```python
import torch

def _softmax(x, axis=-1):
    return torch.softmax(x, dim=axis)
def _gelu(x):
    return torch.nn.functional.gelu(x, approximate="tanh")
def _silu(x):
    return torch.nn.functional.silu(x)
def _sigmoid(x):
    return torch.sigmoid(x)
def _layernorm(x, axis=-1, eps=1e-5):
    m = x.mean(dim=axis, keepdim=True)
    v = x.var(dim=axis, keepdim=True, unbiased=False)
    return (x - m) / torch.sqrt(v + eps)
def _scatter_add(tgt, idx, src, axis=0):
    return tgt.clone().index_add_(axis, idx, src)
def _segment_sum(src, seg, n):
    out = torch.zeros((n,) + src.shape[1:], dtype=src.dtype)
    return out.index_add_(0, seg, src)
def _pad(x, pw):
    flat = tuple(v for pair in reversed(pw) for v in pair)
    return torch.nn.functional.pad(x, flat)

kernel_name = 'concat_heads__sliding_block_cached__gqa_block_cached__decode'

def setup_inputs():

    _w = (lambda a: (lambda t: t.to(torch.bfloat16) if t.is_floating_point() else t)(torch.as_tensor(a)))
    def _A_setup():
        B, Sq, D = 2, 1, 512
        Hq, Hkv, Sk, Dh = 32, 8, 16384, 128
        assert Hq % Hkv == 0, (Hq, Hkv)
        return {
            "x": _w((lambda *s: torch.randn(*s, dtype=torch.bfloat16) * 0.8)(B, Sq, D)),
            "k_cache": _w((lambda *s: torch.randn(*s, dtype=torch.bfloat16) * 1.6)(B, Hkv, Sk, Dh)),
            "v_cache": _w((lambda *s: torch.randn(*s, dtype=torch.bfloat16) * 0.2)(B, Hkv, Sk, Dh)),
            "wq": _w((lambda *s: torch.randn(*s, dtype=torch.bfloat16) * 1.6)(D, Hq * Dh) * (D ** -0.5)),
            "wo": _w((lambda *s: torch.randn(*s, dtype=torch.bfloat16) * 0.2)(Hq * Dh, D) * ((Hq * Dh) ** -0.5)),
        }
    _A_in = _A_setup()

    def _B_setup():
        B, Sq, D = 2, 1, 512
        Hq, Hkv, Sk, Dh = 32, 8, 16384, 128
        assert Hq % Hkv == 0, (Hq, Hkv)
        return {
            "x": _w((lambda *s: torch.randn(*s, dtype=torch.bfloat16) * 0.8)(B, Sq, D)),
            "k_cache": _w((lambda *s: torch.randn(*s, dtype=torch.bfloat16) * 1.6)(B, Hkv, Sk, Dh)),
            "v_cache": _w((lambda *s: torch.randn(*s, dtype=torch.bfloat16) * 0.2)(B, Hkv, Sk, Dh)),
            "wq": _w((lambda *s: torch.randn(*s, dtype=torch.bfloat16) * 1.6)(D, Hq * Dh) * (D ** -0.5)),
            "wo": _w((lambda *s: torch.randn(*s, dtype=torch.bfloat16) * 0.2)(Hq * Dh, D) * ((Hq * Dh) ** -0.5)),
        }
    _B_in = _B_setup()

    return {
        "A_x": _A_in["x"],
        "A_k_cache": _A_in["k_cache"],
        "A_v_cache": _A_in["v_cache"],
        "A_wq": _A_in["wq"],
        "A_wo": _A_in["wo"],
        "B_x": _B_in["x"],
        "B_k_cache": _B_in["k_cache"],
        "B_v_cache": _B_in["v_cache"],
        "B_wq": _B_in["wq"],
        "B_wo": _B_in["wo"],
    }

def reference(A_x, A_k_cache, A_v_cache, A_wq, A_wo, B_x, B_k_cache, B_v_cache, B_wq, B_wo):
    def _A_ref(x, k_cache, v_cache, wq, wo):
        B, Sq, D = x.shape
        Hq, Dh = 32, 128
        Hkv, Sk = k_cache.shape[1], k_cache.shape[2]
        W = min(4096, max(256, Sk // 4))
        rep = Hq // Hkv
        q = (lambda x, *d: x.permute(*d))((x @ wq).reshape(B, Sq, Hq, Dh), 0, 2, 1, 3)
        k = (lambda x, n, axis: torch.repeat_interleave(x, n, dim=axis))(k_cache[:, :, Sk - W:, :], rep, axis=1)
        v = (lambda x, n, axis: torch.repeat_interleave(x, n, dim=axis))(v_cache[:, :, Sk - W:, :], rep, axis=1)
        scores = torch.einsum("bhqd,bhkd->bhqk", q, k) * (Dh ** -0.5)
        p = _softmax(scores, axis=-1)
        o = torch.einsum("bhqk,bhkd->bhqd", p, v)
        return (lambda x, *d: x.permute(*d))(o, 0, 2, 1, 3).reshape(B, Sq, Hq * Dh) @ wo

    def _B_ref(x, k_cache, v_cache, wq, wo):
        B, Sq, D = x.shape
        Hq, Dh = 32, 128
        Hkv = k_cache.shape[1]
        rep = Hq // Hkv
        q = (lambda x, *d: x.permute(*d))((x @ wq).reshape(B, Sq, Hq, Dh), 0, 2, 1, 3)
        k = (lambda x, n, axis: torch.repeat_interleave(x, n, dim=axis))(k_cache, rep, axis=1)
        v = (lambda x, n, axis: torch.repeat_interleave(x, n, dim=axis))(v_cache, rep, axis=1)
        scores = torch.einsum("bhqd,bhkd->bhqk", q, k) * (Dh ** -0.5)
        p = _softmax(scores, axis=-1)
        o = torch.einsum("bhqk,bhkd->bhqd", p, v)
        return (lambda x, *d: x.permute(*d))(o, 0, 2, 1, 3).reshape(B, Sq, Hq * Dh) @ wo

    a = _A_ref(A_x, A_k_cache, A_v_cache, A_wq, A_wo)
    b = _B_ref(B_x, B_k_cache, B_v_cache, B_wq, B_wo)
    return torch.concatenate([a, b], axis=-1)
```

```asm
; @launch grid=(256,1,1) block=(256,1,1) lds=58368
.amdgcn_target "amdgcn-amd-amdhsa--gfx950"
.text
.globl concat_heads__sliding_block_cached__gqa_block_cached__decode_kernel
.p2align 8
.type concat_heads__sliding_block_cached__gqa_block_cached__decode_kernel,@function
concat_heads__sliding_block_cached__gqa_block_cached__decode_kernel:
L_codestart:
    s_cmp_ge_u32 s2, 256
    s_cbranch_scc1 L_end
    s_load_dwordx16 s[4:19], s[0:1], 0
    s_load_dwordx8 s[20:27], s[0:1], 64
    s_load_dwordx2 s[28:29], s[0:1], 96
    v_lshrrev_b32 v1, 6, v0
    v_and_b32 v5, 63, v0
    v_and_b32 v6, 15, v5
    v_lshrrev_b32 v7, 4, v5
    v_readfirstlane_b32 s3, v1
    s_lshr_b32 s68, s2, 3
    s_xor_b32 s69, s3, 3
    s_or_b32 s68, s68, s69
    s_cbranch_scc1 L_nopf0
    s_getpc_b64 s[68:69]
L_pc0:
    s_sub_u32 s68, s68, L_pc0-L_codestart
    s_subb_u32 s69, s69, 0
    v_lshlrev_b32 v243, 4, v5
    s_mov_b32 s70, 13
L_pfl:
    v_min_u32 v244, L_codeend-L_codestart-16, v243
    global_load_dwordx4 v[184:187], v244, s[68:69]
    v_add_u32 v243, 1024, v243
    s_sub_u32 s70, s70, 1
    s_cmp_lg_u32 s70, 0
    s_cbranch_scc1 L_pfl
L_nopf0:
    v_lshrrev_b32 v218, 2, v6
    v_and_b32 v4, 3, v6
    v_lshlrev_b32 v216, 20, v1
    v_lshl_add_u32 v216, v218, 18, v216
    v_lshl_add_u32 v216, v7, 16, v216
    v_lshl_add_u32 v216, v4, 4, v216
    s_and_b32 s68, s2, 7
    s_lshl_b32 s68, s68, 5
    s_lshr_b32 s69, s2, 3
    s_add_u32 s68, s68, s69
    s_lshr_b32 s30, s68, 7
    s_and_b32 s31, s68, 127
    s_lshl_b32 s70, s31, 6
    s_mov_b32 s50, 0x400000
    s_mov_b32 s51, 0x20000
    s_cmp_eq_u32 s30, 0
    s_waitcnt lgkmcnt(0)
    s_cselect_b32 s48, s10, s20
    s_cselect_b32 s49, s11, s21
    s_cselect_b32 s4, s4, s14
    s_cselect_b32 s5, s5, s15
    s_and_b32 s49, s49, 0xffff
    buffer_load_dwordx4 v[136:139], v216, s[48:51], s70 offen nt
    s_add_u32 s70, s70, 8192
    buffer_load_dwordx4 v[140:143], v216, s[48:51], s70 offen nt
    s_add_u32 s70, s70, 8192
    buffer_load_dwordx4 v[144:147], v216, s[48:51], s70 offen nt
    s_add_u32 s70, s70, 8192
    buffer_load_dwordx4 v[148:151], v216, s[48:51], s70 offen nt
    s_add_u32 s70, s70, 8192
    buffer_load_dwordx4 v[152:155], v216, s[48:51], s70 offen nt
    s_add_u32 s70, s70, 8192
    buffer_load_dwordx4 v[156:159], v216, s[48:51], s70 offen nt
    s_add_u32 s70, s70, 8192
    buffer_load_dwordx4 v[160:163], v216, s[48:51], s70 offen nt
    s_add_u32 s70, s70, 8192
    buffer_load_dwordx4 v[164:167], v216, s[48:51], s70 offen nt
    s_load_dword s52, s[28:29], 0
    v_and_b32 v4, 1, v6
    v_lshlrev_b32 v217, 10, v4
    v_lshl_add_u32 v217, v1, 8, v217
    v_lshl_add_u32 v217, v218, 6, v217
    v_lshl_add_u32 v217, v7, 4, v217
    s_mov_b32 s44, s4
    s_and_b32 s45, s5, 0xffff
    s_mov_b32 s46, 0x800
    s_mov_b32 s47, 0x20000
    buffer_load_dwordx4 v[224:227], v217, s[44:47], 0 offen
    s_mov_b32 s32, s28
    s_and_b32 s33, s29, 0xffff
    s_mov_b32 s34, 0x400000
    s_mov_b32 s35, 0x20000
    s_barrier
    v_lshlrev_b32 v2, 8, v6
    v_lshl_add_u32 v2, v7, 4, v2
    v_lshlrev_b32 v3, 10, v7
    v_lshl_add_u32 v3, v6, 4, v3
    s_lshr_b32 s56, s2, 4
    s_and_b32 s57, s2, 15
    s_lshl_b32 s58, s56, 22
    s_mul_i32 s20, s56, 32
    s_mul_i32 s21, s56, 8
    s_lshl_b32 s60, s57, 2
    s_add_u32 s60, s60, s3
    s_add_u32 s61, s60, 64
    s_add_u32 s62, s60, 128
    s_add_u32 s63, s60, 192
    s_add_u32 s64, s60, 256
    s_and_b32 s7, s7, 0xffff
    s_and_b32 s9, s9, 0xffff
    s_and_b32 s17, s17, 0xffff
    s_and_b32 s19, s19, 0xffff
    s_mov_b32 s38, 0x4000000
    s_mov_b32 s39, 0x20000
    s_mov_b32 s42, 0x4000000
    s_mov_b32 s43, 0x20000
    s_add_u32 s68, s60, s20
    s_and_b32 s68, s68, 511
    s_add_u32 s69, s60, s21
    s_and_b32 s69, s69, 127
    s_add_u32 s69, s69, 384
    s_cmp_lt_u32 s60, 512
    s_cselect_b32 s68, s68, s69
    s_cselect_b32 s36, s16, s6
    s_cselect_b32 s37, s17, s7
    s_lshl_b32 s68, s68, 13
    s_add_u32 s68, s68, s58
    s_cmp_lt_u32 s60, 640
    s_cselect_b32 s68, s68, 0x40000000
    s_add_u32 s69, s68, 4096
    buffer_load_dwordx4 v[8:11], v2, s[36:39], s68 offen offset:0 nt
    buffer_load_dwordx4 v[12:15], v2, s[36:39], s68 offen offset:64 nt
    buffer_load_dwordx4 v[16:19], v2, s[36:39], s68 offen offset:128 nt
    buffer_load_dwordx4 v[20:23], v2, s[36:39], s68 offen offset:192 nt
    buffer_load_dwordx4 v[24:27], v2, s[36:39], s69 offen offset:0 nt
    buffer_load_dwordx4 v[28:31], v2, s[36:39], s69 offen offset:64 nt
    buffer_load_dwordx4 v[32:35], v2, s[36:39], s69 offen offset:128 nt
    buffer_load_dwordx4 v[36:39], v2, s[36:39], s69 offen offset:192 nt
    s_mov_b32 s54, 0x05040100
    s_mov_b32 s55, 0x07060302
    s_mov_b32 s53, 0x3e0293ee
    s_mov_b32 s59, 512
    s_mov_b32 s26, 1
    s_lshr_b32 s68, s2, 7
    s_cmp_eq_u32 s68, 0
    s_cselect_b32 s12, s12, s22
    s_cselect_b32 s13, s13, s23
    s_lshl_b32 s68, s56, 12
    s_add_u32 s68, s68, 262144
    s_add_u32 s66, s28, s68
    s_addc_u32 s67, s29, 0
    v_lshl_add_u32 v243, v1, 2, v7
    v_and_b32 v4, 1, v6
    v_lshl_add_u32 v243, v243, 1, v4
    v_lshlrev_b32 v243, 7, v243
    v_cmp_eq_u32 s[68:69], v218, v7
    v_and_b32 v4, 3, v6
    v_cmp_gt_u32 vcc, 2, v4
    s_nop 0
    s_and_b64 s[70:71], s[68:69], vcc
    s_waitcnt vmcnt(8)
    v_perm_b32 v228, v140, v136, s54
    v_perm_b32 v229, v148, v144, s54
    v_perm_b32 v230, v156, v152, s54
    v_perm_b32 v231, v164, v160, s54
    s_nop 1
    v_mfma_f32_16x16x32_bf16 v[184:187], v[228:231], v[224:227], 0
    v_perm_b32 v232, v140, v136, s55
    v_perm_b32 v233, v148, v144, s55
    v_perm_b32 v234, v156, v152, s55
    v_perm_b32 v235, v164, v160, s55
    s_nop 1
    v_mfma_f32_16x16x32_bf16 v[188:191], v[232:235], v[224:227], 0
    v_perm_b32 v236, v141, v137, s54
    v_perm_b32 v237, v149, v145, s54
    v_perm_b32 v238, v157, v153, s54
    v_perm_b32 v239, v165, v161, s54
    s_nop 1
    v_mfma_f32_16x16x32_bf16 v[192:195], v[236:239], v[224:227], 0
    v_perm_b32 v228, v141, v137, s55
    v_perm_b32 v229, v149, v145, s55
    v_perm_b32 v230, v157, v153, s55
    v_perm_b32 v231, v165, v161, s55
    s_nop 1
    v_mfma_f32_16x16x32_bf16 v[196:199], v[228:231], v[224:227], 0
    v_perm_b32 v232, v142, v138, s54
    v_perm_b32 v233, v150, v146, s54
    v_perm_b32 v234, v158, v154, s54
    v_perm_b32 v235, v166, v162, s54
    s_nop 1
    v_mfma_f32_16x16x32_bf16 v[200:203], v[232:235], v[224:227], 0
    v_perm_b32 v236, v142, v138, s55
    v_perm_b32 v237, v150, v146, s55
    v_perm_b32 v238, v158, v154, s55
    v_perm_b32 v239, v166, v162, s55
    s_nop 1
    v_mfma_f32_16x16x32_bf16 v[204:207], v[236:239], v[224:227], 0
    v_perm_b32 v228, v143, v139, s54
    v_perm_b32 v229, v151, v147, s54
    v_perm_b32 v230, v159, v155, s54
    v_perm_b32 v231, v167, v163, s54
    s_nop 1
    v_mfma_f32_16x16x32_bf16 v[208:211], v[228:231], v[224:227], 0
    v_perm_b32 v232, v143, v139, s55
    v_perm_b32 v233, v151, v147, s55
    v_perm_b32 v234, v159, v155, s55
    v_perm_b32 v235, v167, v163, s55
    s_nop 1
    v_mfma_f32_16x16x32_bf16 v[212:215], v[232:235], v[224:227], 0
    s_and_saveexec_b64 s[74:75], s[70:71]
    ds_write_b128 v243, v[184:187] offset:0
    ds_write_b128 v243, v[188:191] offset:16
    ds_write_b128 v243, v[192:195] offset:32
    ds_write_b128 v243, v[196:199] offset:48
    ds_write_b128 v243, v[200:203] offset:64
    ds_write_b128 v243, v[204:207] offset:80
    ds_write_b128 v243, v[208:211] offset:96
    ds_write_b128 v243, v[212:215] offset:112
    s_mov_b64 exec, s[74:75]
    v_lshrrev_b32 v243, 5, v5
    v_and_b32 v244, 31, v5
    v_lshlrev_b32 v245, 7, v243
    v_lshl_add_u32 v245, v244, 2, v245
    v_and_b32 v240, 3, v244
    v_lshlrev_b32 v240, 2, v240
    v_lshrrev_b32 v244, 3, v244
    v_add_u32 v240, v240, v244
    v_lshl_add_u32 v240, v243, 11, v240
    v_lshlrev_b32 v240, 3, v240
    s_lshl_b32 s68, s30, 15
    s_lshl_b32 s69, s31, 7
    s_add_u32 s68, s68, s69
    s_add_u32 s68, s68, 65536
    v_and_b32 v244, 4, v5
    v_cmp_eq_u32 vcc, 0, v244
    s_waitcnt lgkmcnt(0)
    s_mul_i32 s52, s52, 1664525
    s_add_u32 s52, s52, 1013904223
    s_barrier
    s_cmp_lg_u32 s3, 0
    s_cbranch_scc1 L_qpub_join
    s_setprio 3
    ds_read_b32 v184, v245 offset:0
    ds_read_b32 v185, v245 offset:256
    ds_read_b32 v186, v245 offset:512
    ds_read_b32 v187, v245 offset:768
    ds_read_b32 v188, v245 offset:1024
    ds_read_b32 v189, v245 offset:1280
    ds_read_b32 v190, v245 offset:1536
    ds_read_b32 v191, v245 offset:1792
    ds_read_b32 v192, v245 offset:2048
    ds_read_b32 v193, v245 offset:2304
    ds_read_b32 v194, v245 offset:2560
    ds_read_b32 v195, v245 offset:2816
    ds_read_b32 v196, v245 offset:3072
    ds_read_b32 v197, v245 offset:3328
    ds_read_b32 v198, v245 offset:3584
    ds_read_b32 v199, v245 offset:3840
    v_mov_b32 v201, s52
    s_waitcnt lgkmcnt(8)
    v_add_f32 v184, v184, v188
    v_add_f32 v185, v185, v189
    v_add_f32 v186, v186, v190
    v_add_f32 v187, v187, v191
    s_waitcnt lgkmcnt(0)
    v_add_f32 v192, v192, v196
    v_add_f32 v193, v193, v197
    v_add_f32 v194, v194, v198
    v_add_f32 v195, v195, v199
    v_add_f32 v184, v184, v192
    v_add_f32 v185, v185, v193
    v_add_f32 v186, v186, v194
    v_add_f32 v187, v187, v195
    v_add_f32 v184, v184, v185
    v_add_f32 v186, v186, v187
    v_add_f32 v184, v184, v186
    s_nop 1
    v_mov_b32_dpp v185, v184 row_shl:4 row_mask:0xf bank_mask:0xf
    v_cvt_pk_bf16_f32 v200, v184, v185
    s_and_saveexec_b64 s[74:75], vcc
    buffer_store_dwordx2 v[200:201], v240, s[32:35], s68 offen sc1
    s_mov_b64 exec, s[74:75]
    s_setprio 0
L_qpub_join:
    s_barrier
    v_and_b32 v243, 3, v5
    v_bfe_u32 v244, v5, 3, 1
    v_bfe_u32 v245, v5, 2, 1
    v_lshlrev_b32 v240, 12, v244
    v_lshl_add_u32 v240, v243, 6, v240
    v_lshl_add_u32 v240, v7, 2, v240
    v_lshl_add_u32 v240, v245, 1, v240
    v_lshlrev_b32 v240, 3, v240
    s_lshr_b32 s68, s56, 3
    s_lshl_b32 s68, s68, 14
    s_and_b32 s69, s56, 7
    s_lshl_b32 s69, s69, 11
    s_add_u32 s68, s68, s69
    s_lshl_b32 s69, s3, 7
    s_add_u32 s68, s68, s69
    s_add_u32 s5, s68, 65536
    v_lshlrev_b32 v241, 10, v244
    v_lshl_add_u32 v241, v243, 6, v241
    v_lshl_add_u32 v241, v7, 4, v241
    v_lshl_add_u32 v241, v245, 3, v241
    s_lshl_b32 s69, s3, 8
    v_add_u32 v241, s69, v241
    s_add_u32 s68, s60, s20
    s_and_b32 s68, s68, 511
    s_add_u32 s69, s60, s21
    s_and_b32 s69, s69, 127
    s_add_u32 s69, s69, 384
    s_cmp_lt_u32 s60, 512
    s_cselect_b32 s68, s68, s69
    s_cselect_b32 s40, s18, s8
    s_cselect_b32 s41, s19, s9
    s_lshl_b32 s68, s68, 13
    s_add_u32 s68, s68, s58
    s_cmp_lt_u32 s60, 640
    s_cselect_b32 s68, s68, 0x40000000
    s_add_u32 s69, s68, 4096
    buffer_load_dwordx4 v[40:43], v3, s[40:43], s68 offen offset:0 nt
    buffer_load_dwordx4 v[44:47], v3, s[40:43], s68 offen offset:256 nt
    buffer_load_dwordx4 v[48:51], v3, s[40:43], s68 offen offset:512 nt
    buffer_load_dwordx4 v[52:55], v3, s[40:43], s68 offen offset:768 nt
    buffer_load_dwordx4 v[56:59], v3, s[40:43], s69 offen offset:0 nt
    buffer_load_dwordx4 v[60:63], v3, s[40:43], s69 offen offset:256 nt
    buffer_load_dwordx4 v[64:67], v3, s[40:43], s69 offen offset:512 nt
    buffer_load_dwordx4 v[68:71], v3, s[40:43], s69 offen offset:768 nt
    s_add_u32 s68, s61, s20
    s_and_b32 s68, s68, 511
    s_add_u32 s69, s61, s21
    s_and_b32 s69, s69, 127
    s_add_u32 s69, s69, 384
    s_cmp_lt_u32 s61, 512
    s_cselect_b32 s68, s68, s69
    s_cselect_b32 s36, s16, s6
    s_cselect_b32 s37, s17, s7
    s_lshl_b32 s68, s68, 13
    s_add_u32 s68, s68, s58
    s_cmp_lt_u32 s61, 640
    s_cselect_b32 s68, s68, 0x40000000
    s_add_u32 s69, s68, 4096
    buffer_load_dwordx4 v[72:75], v2, s[36:39], s68 offen offset:0 nt
    buffer_load_dwordx4 v[76:79], v2, s[36:39], s68 offen offset:64 nt
    buffer_load_dwordx4 v[80:83], v2, s[36:39], s68 offen offset:128 nt
    buffer_load_dwordx4 v[84:87], v2, s[36:39], s68 offen offset:192 nt
    buffer_load_dwordx4 v[88:91], v2, s[36:39], s69 offen offset:0 nt
    buffer_load_dwordx4 v[92:95], v2, s[36:39], s69 offen offset:64 nt
    buffer_load_dwordx4 v[96:99], v2, s[36:39], s69 offen offset:128 nt
    buffer_load_dwordx4 v[100:103], v2, s[36:39], s69 offen offset:192 nt
    s_barrier
    buffer_load_dwordx4 v[246:249], v240, s[32:35], s5 offen sc1
    s_add_u32 s68, s61, s20
    s_and_b32 s68, s68, 511
    s_add_u32 s69, s61, s21
    s_and_b32 s69, s69, 127
    s_add_u32 s69, s69, 384
    s_cmp_lt_u32 s61, 512
    s_cselect_b32 s68, s68, s69
    s_cselect_b32 s40, s18, s8
    s_cselect_b32 s41, s19, s9
    s_lshl_b32 s68, s68, 13
    s_add_u32 s68, s68, s58
    s_cmp_lt_u32 s61, 640
    s_cselect_b32 s68, s68, 0x40000000
    s_add_u32 s69, s68, 4096
    buffer_load_dwordx4 v[104:107], v3, s[40:43], s68 offen offset:0 nt
    buffer_load_dwordx4 v[108:111], v3, s[40:43], s68 offen offset:256 nt
    buffer_load_dwordx4 v[112:115], v3, s[40:43], s68 offen offset:512 nt
    buffer_load_dwordx4 v[116:119], v3, s[40:43], s68 offen offset:768 nt
    buffer_load_dwordx4 v[120:123], v3, s[40:43], s69 offen offset:0 nt
    buffer_load_dwordx4 v[124:127], v3, s[40:43], s69 offen offset:256 nt
    buffer_load_dwordx4 v[128:131], v3, s[40:43], s69 offen offset:512 nt
    buffer_load_dwordx4 v[132:135], v3, s[40:43], s69 offen offset:768 nt
    buffer_load_dwordx4 v[250:253], v240, s[32:35], s5 offen sc1
    s_add_u32 s68, s62, s20
    s_and_b32 s68, s68, 511
    s_add_u32 s69, s62, s21
    s_and_b32 s69, s69, 127
    s_add_u32 s69, s69, 384
    s_cmp_lt_u32 s62, 512
    s_cselect_b32 s68, s68, s69
    s_cselect_b32 s36, s16, s6
    s_cselect_b32 s37, s17, s7
    s_lshl_b32 s68, s68, 13
    s_add_u32 s68, s68, s58
    s_cmp_lt_u32 s62, 640
    s_cselect_b32 s68, s68, 0x40000000
    s_add_u32 s69, s68, 4096
    buffer_load_dwordx4 v[136:139], v2, s[36:39], s68 offen offset:0 nt
    buffer_load_dwordx4 v[140:143], v2, s[36:39], s68 offen offset:64 nt
    buffer_load_dwordx4 v[144:147], v2, s[36:39], s68 offen offset:128 nt
    buffer_load_dwordx4 v[148:151], v2, s[36:39], s68 offen offset:192 nt
    buffer_load_dwordx4 v[152:155], v2, s[36:39], s69 offen offset:0 nt
    buffer_load_dwordx4 v[156:159], v2, s[36:39], s69 offen offset:64 nt
    buffer_load_dwordx4 v[160:163], v2, s[36:39], s69 offen offset:128 nt
    buffer_load_dwordx4 v[164:167], v2, s[36:39], s69 offen offset:192 nt
    s_waitcnt vmcnt(17)
    v_cmp_eq_u32 vcc, s52, v247
    v_cmp_eq_u32 s[68:69], s52, v249
    s_nop 0
    s_and_b64 vcc, vcc, s[68:69]
    v_mov_b32 v204, v246
    v_mov_b32 v205, v248
    s_cmp_eq_u64 vcc, exec
    s_cbranch_scc1 L_qg_ok
    s_waitcnt vmcnt(8)
    v_cmp_eq_u32 vcc, s52, v251
    v_cmp_eq_u32 s[68:69], s52, v253
    s_nop 0
    s_and_b64 vcc, vcc, s[68:69]
    v_mov_b32 v204, v250
    v_mov_b32 v205, v252
    s_cmp_eq_u64 vcc, exec
    s_cbranch_scc1 L_qg_ok
    s_mov_b32 s4, 131072
L_qg_retry:
    buffer_load_dwordx4 v[246:249], v240, s[32:35], s5 offen sc1
    s_waitcnt vmcnt(0)
    v_cmp_eq_u32 vcc, s52, v247
    v_cmp_eq_u32 s[68:69], s52, v249
    s_nop 0
    s_and_b64 vcc, vcc, s[68:69]
    v_mov_b32 v204, v246
    v_mov_b32 v205, v248
    s_cmp_eq_u64 vcc, exec
    s_cbranch_scc1 L_qg_ok
    s_sub_u32 s4, s4, 1
    s_cbranch_scc0 L_qg_retry
L_qg_ok:
    ds_write_b64 v241, v[204:205] offset:4096
    v_and_b32 v4, 3, v5
    v_lshlrev_b32 v4, 6, v4
    v_lshl_add_u32 v4, v7, 4, v4
    v_and_b32 v1, 3, v5
    s_lshl_b32 s68, s3, 3
    v_add_u32 v1, s68, v1
    v_lshrrev_b32 v7, 4, v5
    v_lshlrev_b32 v6, 9, v1
    v_lshl_add_u32 v6, v7, 4, v6
    v_lshlrev_b32 v7, 3, v1
    v_and_b32 v1, 12, v5
    v_cmp_eq_u32 s[72:73], 0, v1
    s_waitcnt lgkmcnt(0)
    s_mov_b32 s48, s12
    s_and_b32 s49, s13, 0xffff
    s_mov_b32 s50, 0x400000
    s_mov_b32 s51, 0x20000
    v_lshrrev_b32 v254, 4, v5
    v_and_b32 v245, 15, v5
    v_lshlrev_b32 v254, 13, v254
    v_lshl_add_u32 v254, v245, 4, v254
    s_bfe_u32 s65, s2, 0x50002
    s_lshl_b32 s65, s65, 17
    s_lshl_b32 s66, s3, 15
    s_add_u32 s65, s65, s66
    s_and_b32 s66, s2, 3
    s_lshl_b32 s66, s66, 8
    s_add_u32 s65, s65, s66
    s_add_u32 s66, s65, 4096
    s_lshl_b32 s67, s3, 13
    s_add_u32 s67, s67, 25600
    v_mov_b32 v184, 0
    v_mov_b32 v185, 0
    v_mov_b32 v186, 0
    v_mov_b32 v187, 0
    v_mov_b32 v188, 0
    v_mov_b32 v189, 0
    v_mov_b32 v190, 0
    v_mov_b32 v191, 0
    v_mov_b32 v192, 0
    v_mov_b32 v193, 0
    v_mov_b32 v194, 0
    v_mov_b32 v195, 0
    v_mov_b32 v196, 0
    v_mov_b32 v197, 0
    v_mov_b32 v198, 0
    v_mov_b32 v199, 0
    v_mov_b32 v200, 0
    v_mov_b32 v201, 0
    v_mov_b32 v202, 0
    v_mov_b32 v203, 0
    v_mov_b32 v204, 0
    v_mov_b32 v205, 0
    v_mov_b32 v206, 0
    v_mov_b32 v207, 0
    v_mov_b32 v208, 0
    v_mov_b32 v209, 0
    v_mov_b32 v210, 0
    v_mov_b32 v211, 0
    v_mov_b32 v212, 0
    v_mov_b32 v213, 0
    v_mov_b32 v214, 0
    v_mov_b32 v215, 0
    v_mov_b32 v241, 0xff7fffff
    v_mov_b32 v242, 0
    s_barrier
    ds_read_b128 v[168:171], v4 offset:5120
    ds_read_b128 v[172:175], v4 offset:5376
    ds_read_b128 v[176:179], v4 offset:5632
    ds_read_b128 v[180:183], v4 offset:5888
    s_waitcnt lgkmcnt(0)
L_tile0:
    s_cmp_ge_u32 s60, 640
    s_cbranch_scc1 L_exit
L_cont0:
    s_waitcnt vmcnt(16)
    v_mfma_f32_16x16x32_bf16 v[216:219], v[8:11], v[168:171], 0
    v_mfma_f32_16x16x32_bf16 v[220:223], v[24:27], v[168:171], 0
    v_mfma_f32_16x16x32_bf16 v[216:219], v[12:15], v[172:175], v[216:219]
    v_mfma_f32_16x16x32_bf16 v[220:223], v[28:31], v[172:175], v[220:223]
    v_mfma_f32_16x16x32_bf16 v[216:219], v[16:19], v[176:179], v[216:219]
    v_mfma_f32_16x16x32_bf16 v[220:223], v[32:35], v[176:179], v[220:223]
    v_mfma_f32_16x16x32_bf16 v[216:219], v[20:23], v[180:183], v[216:219]
    v_mfma_f32_16x16x32_bf16 v[220:223], v[36:39], v[180:183], v[220:223]
    s_cmp_lg_u32 s26, 0
    s_cbranch_scc1 L_skip0_3
    s_add_u32 s68, s61, s20
    s_and_b32 s68, s68, 511
    s_add_u32 s69, s61, s21
    s_and_b32 s69, s69, 127
    s_add_u32 s69, s69, 384
    s_cmp_lt_u32 s61, 512
    s_cselect_b32 s68, s68, s69
    s_cselect_b32 s40, s18, s8
    s_cselect_b32 s41, s19, s9
    s_lshl_b32 s68, s68, 13
    s_add_u32 s68, s68, s58
    s_cmp_lt_u32 s61, 640
    s_cselect_b32 s68, s68, 0x40000000
    s_add_u32 s69, s68, 4096
    buffer_load_dwordx4 v[104:107], v3, s[40:43], s68 offen offset:0 nt
    buffer_load_dwordx4 v[108:111], v3, s[40:43], s68 offen offset:256 nt
    buffer_load_dwordx4 v[112:115], v3, s[40:43], s68 offen offset:512 nt
    buffer_load_dwordx4 v[116:119], v3, s[40:43], s68 offen offset:768 nt
    buffer_load_dwordx4 v[120:123], v3, s[40:43], s69 offen offset:0 nt
    buffer_load_dwordx4 v[124:127], v3, s[40:43], s69 offen offset:256 nt
    buffer_load_dwordx4 v[128:131], v3, s[40:43], s69 offen offset:512 nt
    buffer_load_dwordx4 v[132:135], v3, s[40:43], s69 offen offset:768 nt
L_skip0_3:
    s_nop 7
    v_max3_f32 v243, v216, v217, v218
    v_max3_f32 v243, v243, v219, v220
    v_max3_f32 v243, v243, v221, v222
    v_max_f32 v243, v243, v223
    v_mov_b32 v244, v243
    s_nop 1
    v_permlane16_swap_b32 v244, v243
    v_max_f32 v243, v243, v244
    v_mov_b32 v244, v243
    s_nop 1
    v_permlane32_swap_b32 v244, v243
    v_max_f32 v243, v243, v244
    v_mul_f32 v243, s53, v243
    v_max_f32 v243, v243, v241
    v_sub_f32 v240, v241, v243
    v_exp_f32 v240, v240
    v_mov_b32 v241, v243
    v_fma_f32 v216, v216, s53, -v241
    v_fma_f32 v217, v217, s53, -v241
    v_fma_f32 v218, v218, s53, -v241
    v_fma_f32 v219, v219, s53, -v241
    v_fma_f32 v220, v220, s53, -v241
    v_fma_f32 v221, v221, s53, -v241
    v_fma_f32 v222, v222, s53, -v241
    v_fma_f32 v223, v223, s53, -v241
    v_exp_f32 v216, v216
    v_exp_f32 v217, v217
    v_exp_f32 v218, v218
    v_exp_f32 v219, v219
    v_exp_f32 v220, v220
    v_exp_f32 v221, v221
    v_exp_f32 v222, v222
    v_exp_f32 v223, v223
    v_pk_mul_f32 v[184:185], v[184:185], v[240:241] op_sel_hi:[1,0]
    v_pk_mul_f32 v[186:187], v[186:187], v[240:241] op_sel_hi:[1,0]
    v_pk_mul_f32 v[188:189], v[188:189], v[240:241] op_sel_hi:[1,0]
    v_pk_mul_f32 v[190:191], v[190:191], v[240:241] op_sel_hi:[1,0]
    v_pk_mul_f32 v[192:193], v[192:193], v[240:241] op_sel_hi:[1,0]
    v_pk_mul_f32 v[194:195], v[194:195], v[240:241] op_sel_hi:[1,0]
    v_pk_mul_f32 v[196:197], v[196:197], v[240:241] op_sel_hi:[1,0]
    v_pk_mul_f32 v[198:199], v[198:199], v[240:241] op_sel_hi:[1,0]
    v_pk_mul_f32 v[200:201], v[200:201], v[240:241] op_sel_hi:[1,0]
    v_pk_mul_f32 v[202:203], v[202:203], v[240:241] op_sel_hi:[1,0]
    v_pk_mul_f32 v[204:205], v[204:205], v[240:241] op_sel_hi:[1,0]
    v_pk_mul_f32 v[206:207], v[206:207], v[240:241] op_sel_hi:[1,0]
    v_pk_mul_f32 v[208:209], v[208:209], v[240:241] op_sel_hi:[1,0]
    v_pk_mul_f32 v[210:211], v[210:211], v[240:241] op_sel_hi:[1,0]
    v_pk_mul_f32 v[212:213], v[212:213], v[240:241] op_sel_hi:[1,0]
    v_pk_mul_f32 v[214:215], v[214:215], v[240:241] op_sel_hi:[1,0]
    v_cvt_pk_bf16_f32 v224, v216, v217
    v_cvt_pk_bf16_f32 v225, v218, v219
    v_cvt_pk_bf16_f32 v226, v220, v221
    v_cvt_pk_bf16_f32 v227, v222, v223
    v_mul_f32 v242, v242, v240
    v_add_f32 v243, v216, v217
    v_add_f32 v244, v218, v219
    v_add_f32 v245, v220, v221
    v_add_f32 v243, v243, v244
    v_add_f32 v244, v222, v223
    v_add_f32 v243, v243, v245
    v_add_f32 v242, v242, v244
    v_add_f32 v242, v242, v243
    s_waitcnt vmcnt(16)
    v_perm_b32 v228, v44, v40, s54
    v_perm_b32 v229, v52, v48, s54
    v_perm_b32 v230, v60, v56, s54
    v_perm_b32 v231, v68, v64, s54
    s_nop 1
    v_mfma_f32_16x16x32_bf16 v[184:187], v[228:231], v[224:227], v[184:187]
    v_perm_b32 v232, v44, v40, s55
    v_perm_b32 v233, v52, v48, s55
    v_perm_b32 v234, v60, v56, s55
    v_perm_b32 v235, v68, v64, s55
    s_nop 1
    v_mfma_f32_16x16x32_bf16 v[188:191], v[232:235], v[224:227], v[188:191]
    v_perm_b32 v236, v45, v41, s54
    v_perm_b32 v237, v53, v49, s54
    v_perm_b32 v238, v61, v57, s54
    v_perm_b32 v239, v69, v65, s54
    s_nop 1
    v_mfma_f32_16x16x32_bf16 v[192:195], v[236:239], v[224:227], v[192:195]
    v_perm_b32 v228, v45, v41, s55
    v_perm_b32 v229, v53, v49, s55
    v_perm_b32 v230, v61, v57, s55
    v_perm_b32 v231, v69, v65, s55
    s_nop 1
    v_mfma_f32_16x16x32_bf16 v[196:199], v[228:231], v[224:227], v[196:199]
    v_perm_b32 v232, v46, v42, s54
    v_perm_b32 v233, v54, v50, s54
    v_perm_b32 v234, v62, v58, s54
    v_perm_b32 v235, v70, v66, s54
    s_nop 1
    v_mfma_f32_16x16x32_bf16 v[200:203], v[232:235], v[224:227], v[200:203]
    v_perm_b32 v236, v46, v42, s55
    v_perm_b32 v237, v54, v50, s55
    v_perm_b32 v238, v62, v58, s55
    v_perm_b32 v239, v70, v66, s55
    s_nop 1
    v_mfma_f32_16x16x32_bf16 v[204:207], v[236:239], v[224:227], v[204:207]
    v_perm_b32 v228, v47, v43, s54
    v_perm_b32 v229, v55, v51, s54
    v_perm_b32 v230, v63, v59, s54
    v_perm_b32 v231, v71, v67, s54
    s_nop 1
    v_mfma_f32_16x16x32_bf16 v[208:211], v[228:231], v[224:227], v[208:211]
    v_perm_b32 v232, v47, v43, s55
    v_perm_b32 v233, v55, v51, s55
    v_perm_b32 v234, v63, v59, s55
    v_perm_b32 v235, v71, v67, s55
    s_add_u32 s62, s60, 128
    s_cmp_lg_u32 s26, 0
    s_cbranch_scc1 L_skip0_4
    s_add_u32 s68, s62, s20
    s_and_b32 s68, s68, 511
    s_add_u32 s69, s62, s21
    s_and_b32 s69, s69, 127
    s_add_u32 s69, s69, 384
    s_cmp_lt_u32 s62, 512
    s_cselect_b32 s68, s68, s69
    s_cselect_b32 s36, s16, s6
    s_cselect_b32 s37, s17, s7
    s_lshl_b32 s68, s68, 13
    s_add_u32 s68, s68, s58
    s_cmp_lt_u32 s62, 640
    s_cselect_b32 s68, s68, 0x40000000
    s_add_u32 s69, s68, 4096
    buffer_load_dwordx4 v[136:139], v2, s[36:39], s68 offen offset:0 nt
    buffer_load_dwordx4 v[140:143], v2, s[36:39], s68 offen offset:64 nt
    buffer_load_dwordx4 v[144:147], v2, s[36:39], s68 offen offset:128 nt
    buffer_load_dwordx4 v[148:151], v2, s[36:39], s68 offen offset:192 nt
    buffer_load_dwordx4 v[152:155], v2, s[36:39], s69 offen offset:0 nt
    buffer_load_dwordx4 v[156:159], v2, s[36:39], s69 offen offset:64 nt
    buffer_load_dwordx4 v[160:163], v2, s[36:39], s69 offen offset:128 nt
    buffer_load_dwordx4 v[164:167], v2, s[36:39], s69 offen offset:192 nt
L_skip0_4:
    s_nop 7
    v_mfma_f32_16x16x32_bf16 v[212:215], v[232:235], v[224:227], v[212:215]
L_tile1:
L_cont1:
    s_waitcnt vmcnt(16)
    v_mfma_f32_16x16x32_bf16 v[216:219], v[72:75], v[168:171], 0
    v_mfma_f32_16x16x32_bf16 v[220:223], v[88:91], v[168:171], 0
    v_mfma_f32_16x16x32_bf16 v[216:219], v[76:79], v[172:175], v[216:219]
    v_mfma_f32_16x16x32_bf16 v[220:223], v[92:95], v[172:175], v[220:223]
    v_mfma_f32_16x16x32_bf16 v[216:219], v[80:83], v[176:179], v[216:219]
    v_mfma_f32_16x16x32_bf16 v[220:223], v[96:99], v[176:179], v[220:223]
    v_mfma_f32_16x16x32_bf16 v[216:219], v[84:87], v[180:183], v[216:219]
    v_mfma_f32_16x16x32_bf16 v[220:223], v[100:103], v[180:183], v[220:223]
    s_add_u32 s68, s62, s20
    s_and_b32 s68, s68, 511
    s_add_u32 s69, s62, s21
    s_and_b32 s69, s69, 127
    s_add_u32 s69, s69, 384
    s_cmp_lt_u32 s62, 512
    s_cselect_b32 s68, s68, s69
    s_cselect_b32 s40, s18, s8
    s_cselect_b32 s41, s19, s9
    s_lshl_b32 s68, s68, 13
    s_add_u32 s68, s68, s58
    s_cmp_lt_u32 s62, 640
    s_cselect_b32 s68, s68, 0x40000000
    s_add_u32 s69, s68, 4096
    buffer_load_dwordx4 v[8:11], v3, s[40:43], s68 offen offset:0 nt
    buffer_load_dwordx4 v[12:15], v3, s[40:43], s68 offen offset:256 nt
    buffer_load_dwordx4 v[16:19], v3, s[40:43], s68 offen offset:512 nt
    buffer_load_dwordx4 v[20:23], v3, s[40:43], s68 offen offset:768 nt
    buffer_load_dwordx4 v[24:27], v3, s[40:43], s69 offen offset:0 nt
    buffer_load_dwordx4 v[28:31], v3, s[40:43], s69 offen offset:256 nt
    buffer_load_dwordx4 v[32:35], v3, s[40:43], s69 offen offset:512 nt
    buffer_load_dwordx4 v[36:39], v3, s[40:43], s69 offen offset:768 nt
    v_max3_f32 v243, v216, v217, v218
    v_max3_f32 v243, v243, v219, v220
    v_max3_f32 v243, v243, v221, v222
    v_max_f32 v243, v243, v223
    v_mov_b32 v244, v243
    s_nop 1
    v_permlane16_swap_b32 v244, v243
    v_max_f32 v243, v243, v244
    v_mov_b32 v244, v243
    s_nop 1
    v_permlane32_swap_b32 v244, v243
    v_max_f32 v243, v243, v244
    v_mul_f32 v243, s53, v243
    v_max_f32 v243, v243, v241
    v_sub_f32 v240, v241, v243
    v_exp_f32 v240, v240
    v_mov_b32 v241, v243
    v_fma_f32 v216, v216, s53, -v241
    v_fma_f32 v217, v217, s53, -v241
    v_fma_f32 v218, v218, s53, -v241
    v_fma_f32 v219, v219, s53, -v241
    v_fma_f32 v220, v220, s53, -v241
    v_fma_f32 v221, v221, s53, -v241
    v_fma_f32 v222, v222, s53, -v241
    v_fma_f32 v223, v223, s53, -v241
    v_exp_f32 v216, v216
    v_exp_f32 v217, v217
    v_exp_f32 v218, v218
    v_exp_f32 v219, v219
    v_exp_f32 v220, v220
    v_exp_f32 v221, v221
    v_exp_f32 v222, v222
    v_exp_f32 v223, v223
    v_pk_mul_f32 v[184:185], v[184:185], v[240:241] op_sel_hi:[1,0]
    v_pk_mul_f32 v[186:187], v[186:187], v[240:241] op_sel_hi:[1,0]
    v_pk_mul_f32 v[188:189], v[188:189], v[240:241] op_sel_hi:[1,0]
    v_pk_mul_f32 v[190:191], v[190:191], v[240:241] op_sel_hi:[1,0]
    v_pk_mul_f32 v[192:193], v[192:193], v[240:241] op_sel_hi:[1,0]
    v_pk_mul_f32 v[194:195], v[194:195], v[240:241] op_sel_hi:[1,0]
    v_pk_mul_f32 v[196:197], v[196:197], v[240:241] op_sel_hi:[1,0]
    v_pk_mul_f32 v[198:199], v[198:199], v[240:241] op_sel_hi:[1,0]
    v_pk_mul_f32 v[200:201], v[200:201], v[240:241] op_sel_hi:[1,0]
    v_pk_mul_f32 v[202:203], v[202:203], v[240:241] op_sel_hi:[1,0]
    v_pk_mul_f32 v[204:205], v[204:205], v[240:241] op_sel_hi:[1,0]
    v_pk_mul_f32 v[206:207], v[206:207], v[240:241] op_sel_hi:[1,0]
    v_pk_mul_f32 v[208:209], v[208:209], v[240:241] op_sel_hi:[1,0]
    v_pk_mul_f32 v[210:211], v[210:211], v[240:241] op_sel_hi:[1,0]
    v_pk_mul_f32 v[212:213], v[212:213], v[240:241] op_sel_hi:[1,0]
    v_pk_mul_f32 v[214:215], v[214:215], v[240:241] op_sel_hi:[1,0]
    v_cvt_pk_bf16_f32 v224, v216, v217
    v_cvt_pk_bf16_f32 v225, v218, v219
    v_cvt_pk_bf16_f32 v226, v220, v221
    v_cvt_pk_bf16_f32 v227, v222, v223
    v_mul_f32 v242, v242, v240
    v_add_f32 v243, v216, v217
    v_add_f32 v244, v218, v219
    v_add_f32 v245, v220, v221
    v_add_f32 v243, v243, v244
    v_add_f32 v244, v222, v223
    v_add_f32 v243, v243, v245
    v_add_f32 v242, v242, v244
    v_add_f32 v242, v242, v243
    s_waitcnt vmcnt(16)
    v_perm_b32 v228, v108, v104, s54
    v_perm_b32 v229, v116, v112, s54
    v_perm_b32 v230, v124, v120, s54
    v_perm_b32 v231, v132, v128, s54
    s_nop 1
    v_mfma_f32_16x16x32_bf16 v[184:187], v[228:231], v[224:227], v[184:187]
    v_perm_b32 v232, v108, v104, s55
    v_perm_b32 v233, v116, v112, s55
    v_perm_b32 v234, v124, v120, s55
    v_perm_b32 v235, v132, v128, s55
    s_nop 1
    v_mfma_f32_16x16x32_bf16 v[188:191], v[232:235], v[224:227], v[188:191]
    v_perm_b32 v236, v109, v105, s54
    v_perm_b32 v237, v117, v113, s54
    v_perm_b32 v238, v125, v121, s54
    v_perm_b32 v239, v133, v129, s54
    s_nop 1
    v_mfma_f32_16x16x32_bf16 v[192:195], v[236:239], v[224:227], v[192:195]
    v_perm_b32 v228, v109, v105, s55
    v_perm_b32 v229, v117, v113, s55
    v_perm_b32 v230, v125, v121, s55
    v_perm_b32 v231, v133, v129, s55
    s_nop 1
    v_mfma_f32_16x16x32_bf16 v[196:199], v[228:231], v[224:227], v[196:199]
    v_perm_b32 v232, v110, v106, s54
    v_perm_b32 v233, v118, v114, s54
    v_perm_b32 v234, v126, v122, s54
    v_perm_b32 v235, v134, v130, s54
    s_nop 1
    v_mfma_f32_16x16x32_bf16 v[200:203], v[232:235], v[224:227], v[200:203]
    v_perm_b32 v236, v110, v106, s55
    v_perm_b32 v237, v118, v114, s55
    v_perm_b32 v238, v126, v122, s55
    v_perm_b32 v239, v134, v130, s55
    s_nop 1
    v_mfma_f32_16x16x32_bf16 v[204:207], v[236:239], v[224:227], v[204:207]
    v_perm_b32 v228, v111, v107, s54
    v_perm_b32 v229, v119, v115, s54
    v_perm_b32 v230, v127, v123, s54
    v_perm_b32 v231, v135, v131, s54
    s_nop 1
    v_mfma_f32_16x16x32_bf16 v[208:211], v[228:231], v[224:227], v[208:211]
    v_perm_b32 v232, v111, v107, s55
    v_perm_b32 v233, v119, v115, s55
    v_perm_b32 v234, v127, v123, s55
    v_perm_b32 v235, v135, v131, s55
    s_add_u32 s63, s61, 128
    s_add_u32 s68, s63, s20
    s_and_b32 s68, s68, 511
    s_add_u32 s69, s63, s21
    s_and_b32 s69, s69, 127
    s_add_u32 s69, s69, 384
    s_cmp_lt_u32 s63, 512
    s_cselect_b32 s68, s68, s69
    s_cselect_b32 s36, s16, s6
    s_cselect_b32 s37, s17, s7
    s_lshl_b32 s68, s68, 13
    s_add_u32 s68, s68, s58
    s_cmp_lt_u32 s63, 640
    s_cselect_b32 s68, s68, 0x40000000
    s_add_u32 s69, s68, 4096
    buffer_load_dwordx4 v[40:43], v2, s[36:39], s68 offen offset:0 nt
    buffer_load_dwordx4 v[44:47], v2, s[36:39], s68 offen offset:64 nt
    buffer_load_dwordx4 v[48:51], v2, s[36:39], s68 offen offset:128 nt
    buffer_load_dwordx4 v[52:55], v2, s[36:39], s68 offen offset:192 nt
    buffer_load_dwordx4 v[56:59], v2, s[36:39], s69 offen offset:0 nt
    buffer_load_dwordx4 v[60:63], v2, s[36:39], s69 offen offset:64 nt
    buffer_load_dwordx4 v[64:67], v2, s[36:39], s69 offen offset:128 nt
    buffer_load_dwordx4 v[68:71], v2, s[36:39], s69 offen offset:192 nt
    v_mfma_f32_16x16x32_bf16 v[212:215], v[232:235], v[224:227], v[212:215]
L_tile2:
L_cont2:
    s_waitcnt vmcnt(16)
    v_mfma_f32_16x16x32_bf16 v[216:219], v[136:139], v[168:171], 0
    v_mfma_f32_16x16x32_bf16 v[220:223], v[152:155], v[168:171], 0
    v_mfma_f32_16x16x32_bf16 v[216:219], v[140:143], v[172:175], v[216:219]
    v_mfma_f32_16x16x32_bf16 v[220:223], v[156:159], v[172:175], v[220:223]
    v_mfma_f32_16x16x32_bf16 v[216:219], v[144:147], v[176:179], v[216:219]
    v_mfma_f32_16x16x32_bf16 v[220:223], v[160:163], v[176:179], v[220:223]
    v_mfma_f32_16x16x32_bf16 v[216:219], v[148:151], v[180:183], v[216:219]
    v_mfma_f32_16x16x32_bf16 v[220:223], v[164:167], v[180:183], v[220:223]
    s_add_u32 s68, s63, s20
    s_and_b32 s68, s68, 511
    s_add_u32 s69, s63, s21
    s_and_b32 s69, s69, 127
    s_add_u32 s69, s69, 384
    s_cmp_lt_u32 s63, 512
    s_cselect_b32 s68, s68, s69
    s_cselect_b32 s40, s18, s8
    s_cselect_b32 s41, s19, s9
    s_lshl_b32 s68, s68, 13
    s_add_u32 s68, s68, s58
    s_cmp_lt_u32 s63, 640
    s_cselect_b32 s68, s68, 0x40000000
    s_add_u32 s69, s68, 4096
    buffer_load_dwordx4 v[72:75], v3, s[40:43], s68 offen offset:0 nt
    buffer_load_dwordx4 v[76:79], v3, s[40:43], s68 offen offset:256 nt
    buffer_load_dwordx4 v[80:83], v3, s[40:43], s68 offen offset:512 nt
    buffer_load_dwordx4 v[84:87], v3, s[40:43], s68 offen offset:768 nt
    buffer_load_dwordx4 v[88:91], v3, s[40:43], s69 offen offset:0 nt
    buffer_load_dwordx4 v[92:95], v3, s[40:43], s69 offen offset:256 nt
    buffer_load_dwordx4 v[96:99], v3, s[40:43], s69 offen offset:512 nt
    buffer_load_dwordx4 v[100:103], v3, s[40:43], s69 offen offset:768 nt
    v_max3_f32 v243, v216, v217, v218
    v_max3_f32 v243, v243, v219, v220
    v_max3_f32 v243, v243, v221, v222
    v_max_f32 v243, v243, v223
    v_mov_b32 v244, v243
    s_nop 1
    v_permlane16_swap_b32 v244, v243
    v_max_f32 v243, v243, v244
    v_mov_b32 v244, v243
    s_nop 1
    v_permlane32_swap_b32 v244, v243
    v_max_f32 v243, v243, v244
    v_mul_f32 v243, s53, v243
    v_max_f32 v243, v243, v241
    v_sub_f32 v240, v241, v243
    v_exp_f32 v240, v240
    v_mov_b32 v241, v243
    v_fma_f32 v216, v216, s53, -v241
    v_fma_f32 v217, v217, s53, -v241
    v_fma_f32 v218, v218, s53, -v241
    v_fma_f32 v219, v219, s53, -v241
    v_fma_f32 v220, v220, s53, -v241
    v_fma_f32 v221, v221, s53, -v241
    v_fma_f32 v222, v222, s53, -v241
    v_fma_f32 v223, v223, s53, -v241
    v_exp_f32 v216, v216
    v_exp_f32 v217, v217
    v_exp_f32 v218, v218
    v_exp_f32 v219, v219
    v_exp_f32 v220, v220
    v_exp_f32 v221, v221
    v_exp_f32 v222, v222
    v_exp_f32 v223, v223
    v_pk_mul_f32 v[184:185], v[184:185], v[240:241] op_sel_hi:[1,0]
    v_pk_mul_f32 v[186:187], v[186:187], v[240:241] op_sel_hi:[1,0]
    v_pk_mul_f32 v[188:189], v[188:189], v[240:241] op_sel_hi:[1,0]
    v_pk_mul_f32 v[190:191], v[190:191], v[240:241] op_sel_hi:[1,0]
    v_pk_mul_f32 v[192:193], v[192:193], v[240:241] op_sel_hi:[1,0]
    v_pk_mul_f32 v[194:195], v[194:195], v[240:241] op_sel_hi:[1,0]
    v_pk_mul_f32 v[196:197], v[196:197], v[240:241] op_sel_hi:[1,0]
    v_pk_mul_f32 v[198:199], v[198:199], v[240:241] op_sel_hi:[1,0]
    v_pk_mul_f32 v[200:201], v[200:201], v[240:241] op_sel_hi:[1,0]
    v_pk_mul_f32 v[202:203], v[202:203], v[240:241] op_sel_hi:[1,0]
    v_pk_mul_f32 v[204:205], v[204:205], v[240:241] op_sel_hi:[1,0]
    v_pk_mul_f32 v[206:207], v[206:207], v[240:241] op_sel_hi:[1,0]
    v_pk_mul_f32 v[208:209], v[208:209], v[240:241] op_sel_hi:[1,0]
    v_pk_mul_f32 v[210:211], v[210:211], v[240:241] op_sel_hi:[1,0]
    v_pk_mul_f32 v[212:213], v[212:213], v[240:241] op_sel_hi:[1,0]
    v_pk_mul_f32 v[214:215], v[214:215], v[240:241] op_sel_hi:[1,0]
    v_cvt_pk_bf16_f32 v224, v216, v217
    v_cvt_pk_bf16_f32 v225, v218, v219
    v_cvt_pk_bf16_f32 v226, v220, v221
    v_cvt_pk_bf16_f32 v227, v222, v223
    v_mul_f32 v242, v242, v240
    v_add_f32 v243, v216, v217
    v_add_f32 v244, v218, v219
    v_add_f32 v245, v220, v221
    v_add_f32 v243, v243, v244
    v_add_f32 v244, v222, v223
    v_add_f32 v243, v243, v245
    v_add_f32 v242, v242, v244
    v_add_f32 v242, v242, v243
    s_waitcnt vmcnt(16)
    v_perm_b32 v228, v12, v8, s54
    v_perm_b32 v229, v20, v16, s54
    v_perm_b32 v230, v28, v24, s54
    v_perm_b32 v231, v36, v32, s54
    s_nop 1
    v_mfma_f32_16x16x32_bf16 v[184:187], v[228:231], v[224:227], v[184:187]
    v_perm_b32 v232, v12, v8, s55
    v_perm_b32 v233, v20, v16, s55
    v_perm_b32 v234, v28, v24, s55
    v_perm_b32 v235, v36, v32, s55
    s_nop 1
    v_mfma_f32_16x16x32_bf16 v[188:191], v[232:235], v[224:227], v[188:191]
    v_perm_b32 v236, v13, v9, s54
    v_perm_b32 v237, v21, v17, s54
    v_perm_b32 v238, v29, v25, s54
    v_perm_b32 v239, v37, v33, s54
    s_nop 1
    v_mfma_f32_16x16x32_bf16 v[192:195], v[236:239], v[224:227], v[192:195]
    v_perm_b32 v228, v13, v9, s55
    v_perm_b32 v229, v21, v17, s55
    v_perm_b32 v230, v29, v25, s55
    v_perm_b32 v231, v37, v33, s55
    s_nop 1
    v_mfma_f32_16x16x32_bf16 v[196:199], v[228:231], v[224:227], v[196:199]
    v_perm_b32 v232, v14, v10, s54
    v_perm_b32 v233, v22, v18, s54
    v_perm_b32 v234, v30, v26, s54
    v_perm_b32 v235, v38, v34, s54
    s_nop 1
    v_mfma_f32_16x16x32_bf16 v[200:203], v[232:235], v[224:227], v[200:203]
    v_perm_b32 v236, v14, v10, s55
    v_perm_b32 v237, v22, v18, s55
    v_perm_b32 v238, v30, v26, s55
    v_perm_b32 v239, v38, v34, s55
    s_nop 1
    v_mfma_f32_16x16x32_bf16 v[204:207], v[236:239], v[224:227], v[204:207]
    v_perm_b32 v228, v15, v11, s54
    v_perm_b32 v229, v23, v19, s54
    v_perm_b32 v230, v31, v27, s54
    v_perm_b32 v231, v39, v35, s54
    s_nop 1
    v_mfma_f32_16x16x32_bf16 v[208:211], v[228:231], v[224:227], v[208:211]
    v_perm_b32 v232, v15, v11, s55
    v_perm_b32 v233, v23, v19, s55
    v_perm_b32 v234, v31, v27, s55
    v_perm_b32 v235, v39, v35, s55
    s_add_u32 s64, s62, 128
    s_add_u32 s68, s64, s20
    s_and_b32 s68, s68, 511
    s_add_u32 s69, s64, s21
    s_and_b32 s69, s69, 127
    s_add_u32 s69, s69, 384
    s_cmp_lt_u32 s64, 512
    s_cselect_b32 s68, s68, s69
    s_cselect_b32 s36, s16, s6
    s_cselect_b32 s37, s17, s7
    s_lshl_b32 s68, s68, 13
    s_add_u32 s68, s68, s58
    s_cmp_lt_u32 s64, 640
    s_cselect_b32 s68, s68, 0x40000000
    s_add_u32 s69, s68, 4096
    buffer_load_dwordx4 v[104:107], v2, s[36:39], s68 offen offset:0 nt
    buffer_load_dwordx4 v[108:111], v2, s[36:39], s68 offen offset:64 nt
    buffer_load_dwordx4 v[112:115], v2, s[36:39], s68 offen offset:128 nt
    buffer_load_dwordx4 v[116:119], v2, s[36:39], s68 offen offset:192 nt
    buffer_load_dwordx4 v[120:123], v2, s[36:39], s69 offen offset:0 nt
    buffer_load_dwordx4 v[124:127], v2, s[36:39], s69 offen offset:64 nt
    buffer_load_dwordx4 v[128:131], v2, s[36:39], s69 offen offset:128 nt
    buffer_load_dwordx4 v[132:135], v2, s[36:39], s69 offen offset:192 nt
    v_mfma_f32_16x16x32_bf16 v[212:215], v[232:235], v[224:227], v[212:215]
    s_mov_b32 s26, 0
L_tile3:
    s_cmp_ge_u32 s63, s59
    s_cbranch_scc1 L_switch3
L_cont3:
    s_waitcnt vmcnt(16)
    v_mfma_f32_16x16x32_bf16 v[216:219], v[40:43], v[168:171], 0
    v_mfma_f32_16x16x32_bf16 v[220:223], v[56:59], v[168:171], 0
    v_mfma_f32_16x16x32_bf16 v[216:219], v[44:47], v[172:175], v[216:219]
    v_mfma_f32_16x16x32_bf16 v[220:223], v[60:63], v[172:175], v[220:223]
    v_mfma_f32_16x16x32_bf16 v[216:219], v[48:51], v[176:179], v[216:219]
    v_mfma_f32_16x16x32_bf16 v[220:223], v[64:67], v[176:179], v[220:223]
    v_mfma_f32_16x16x32_bf16 v[216:219], v[52:55], v[180:183], v[216:219]
    v_mfma_f32_16x16x32_bf16 v[220:223], v[68:71], v[180:183], v[220:223]
    s_add_u32 s68, s64, s20
    s_and_b32 s68, s68, 511
    s_add_u32 s69, s64, s21
    s_and_b32 s69, s69, 127
    s_add_u32 s69, s69, 384
    s_cmp_lt_u32 s64, 512
    s_cselect_b32 s68, s68, s69
    s_cselect_b32 s40, s18, s8
    s_cselect_b32 s41, s19, s9
    s_lshl_b32 s68, s68, 13
    s_add_u32 s68, s68, s58
    s_cmp_lt_u32 s64, 640
    s_cselect_b32 s68, s68, 0x40000000
    s_add_u32 s69, s68, 4096
    buffer_load_dwordx4 v[136:139], v3, s[40:43], s68 offen offset:0 nt
    buffer_load_dwordx4 v[140:143], v3, s[40:43], s68 offen offset:256 nt
    buffer_load_dwordx4 v[144:147], v3, s[40:43], s68 offen offset:512 nt
    buffer_load_dwordx4 v[148:151], v3, s[40:43], s68 offen offset:768 nt
    buffer_load_dwordx4 v[152:155], v3, s[40:43], s69 offen offset:0 nt
    buffer_load_dwordx4 v[156:159], v3, s[40:43], s69 offen offset:256 nt
    buffer_load_dwordx4 v[160:163], v3, s[40:43], s69 offen offset:512 nt
    buffer_load_dwordx4 v[164:167], v3, s[40:43], s69 offen offset:768 nt
    v_max3_f32 v243, v216, v217, v218
    v_max3_f32 v243, v243, v219, v220
    v_max3_f32 v243, v243, v221, v222
    v_max_f32 v243, v243, v223
    v_mov_b32 v244, v243
    s_nop 1
    v_permlane16_swap_b32 v244, v243
    v_max_f32 v243, v243, v244
    v_mov_b32 v244, v243
    s_nop 1
    v_permlane32_swap_b32 v244, v243
    v_max_f32 v243, v243, v244
    v_mul_f32 v243, s53, v243
    v_max_f32 v243, v243, v241
    v_sub_f32 v240, v241, v243
    v_exp_f32 v240, v240
    v_mov_b32 v241, v243
    v_fma_f32 v216, v216, s53, -v241
    v_fma_f32 v217, v217, s53, -v241
    v_fma_f32 v218, v218, s53, -v241
    v_fma_f32 v219, v219, s53, -v241
    v_fma_f32 v220, v220, s53, -v241
    v_fma_f32 v221, v221, s53, -v241
    v_fma_f32 v222, v222, s53, -v241
    v_fma_f32 v223, v223, s53, -v241
    v_exp_f32 v216, v216
    v_exp_f32 v217, v217
    v_exp_f32 v218, v218
    v_exp_f32 v219, v219
    v_exp_f32 v220, v220
    v_exp_f32 v221, v221
    v_exp_f32 v222, v222
    v_exp_f32 v223, v223
    v_pk_mul_f32 v[184:185], v[184:185], v[240:241] op_sel_hi:[1,0]
    v_pk_mul_f32 v[186:187], v[186:187], v[240:241] op_sel_hi:[1,0]
    v_pk_mul_f32 v[188:189], v[188:189], v[240:241] op_sel_hi:[1,0]
    v_pk_mul_f32 v[190:191], v[190:191], v[240:241] op_sel_hi:[1,0]
    v_pk_mul_f32 v[192:193], v[192:193], v[240:241] op_sel_hi:[1,0]
    v_pk_mul_f32 v[194:195], v[194:195], v[240:241] op_sel_hi:[1,0]
    v_pk_mul_f32 v[196:197], v[196:197], v[240:241] op_sel_hi:[1,0]
    v_pk_mul_f32 v[198:199], v[198:199], v[240:241] op_sel_hi:[1,0]
    v_pk_mul_f32 v[200:201], v[200:201], v[240:241] op_sel_hi:[1,0]
    v_pk_mul_f32 v[202:203], v[202:203], v[240:241] op_sel_hi:[1,0]
    v_pk_mul_f32 v[204:205], v[204:205], v[240:241] op_sel_hi:[1,0]
    v_pk_mul_f32 v[206:207], v[206:207], v[240:241] op_sel_hi:[1,0]
    v_pk_mul_f32 v[208:209], v[208:209], v[240:241] op_sel_hi:[1,0]
    v_pk_mul_f32 v[210:211], v[210:211], v[240:241] op_sel_hi:[1,0]
    v_pk_mul_f32 v[212:213], v[212:213], v[240:241] op_sel_hi:[1,0]
    v_pk_mul_f32 v[214:215], v[214:215], v[240:241] op_sel_hi:[1,0]
    v_cvt_pk_bf16_f32 v224, v216, v217
    v_cvt_pk_bf16_f32 v225, v218, v219
    v_cvt_pk_bf16_f32 v226, v220, v221
    v_cvt_pk_bf16_f32 v227, v222, v223
    v_mul_f32 v242, v242, v240
    v_add_f32 v243, v216, v217
    v_add_f32 v244, v218, v219
    v_add_f32 v245, v220, v221
    v_add_f32 v243, v243, v244
    v_add_f32 v244, v222, v223
    v_add_f32 v243, v243, v245
    v_add_f32 v242, v242, v244
    v_add_f32 v242, v242, v243
    s_waitcnt vmcnt(16)
    v_perm_b32 v228, v76, v72, s54
    v_perm_b32 v229, v84, v80, s54
    v_perm_b32 v230, v92, v88, s54
    v_perm_b32 v231, v100, v96, s54
    s_nop 1
    v_mfma_f32_16x16x32_bf16 v[184:187], v[228:231], v[224:227], v[184:187]
    v_perm_b32 v232, v76, v72, s55
    v_perm_b32 v233, v84, v80, s55
    v_perm_b32 v234, v92, v88, s55
    v_perm_b32 v235, v100, v96, s55
    s_nop 1
    v_mfma_f32_16x16x32_bf16 v[188:191], v[232:235], v[224:227], v[188:191]
    v_perm_b32 v236, v77, v73, s54
    v_perm_b32 v237, v85, v81, s54
    v_perm_b32 v238, v93, v89, s54
    v_perm_b32 v239, v101, v97, s54
    s_nop 1
    v_mfma_f32_16x16x32_bf16 v[192:195], v[236:239], v[224:227], v[192:195]
    v_perm_b32 v228, v77, v73, s55
    v_perm_b32 v229, v85, v81, s55
    v_perm_b32 v230, v93, v89, s55
    v_perm_b32 v231, v101, v97, s55
    s_nop 1
    v_mfma_f32_16x16x32_bf16 v[196:199], v[228:231], v[224:227], v[196:199]
    v_perm_b32 v232, v78, v74, s54
    v_perm_b32 v233, v86, v82, s54
    v_perm_b32 v234, v94, v90, s54
    v_perm_b32 v235, v102, v98, s54
    s_nop 1
    v_mfma_f32_16x16x32_bf16 v[200:203], v[232:235], v[224:227], v[200:203]
    v_perm_b32 v236, v78, v74, s55
    v_perm_b32 v237, v86, v82, s55
    v_perm_b32 v238, v94, v90, s55
    v_perm_b32 v239, v102, v98, s55
    s_nop 1
    v_mfma_f32_16x16x32_bf16 v[204:207], v[236:239], v[224:227], v[204:207]
    v_perm_b32 v228, v79, v75, s54
    v_perm_b32 v229, v87, v83, s54
    v_perm_b32 v230, v95, v91, s54
    v_perm_b32 v231, v103, v99, s54
    s_nop 1
    v_mfma_f32_16x16x32_bf16 v[208:211], v[228:231], v[224:227], v[208:211]
    v_perm_b32 v232, v79, v75, s55
    v_perm_b32 v233, v87, v83, s55
    v_perm_b32 v234, v95, v91, s55
    v_perm_b32 v235, v103, v99, s55
    s_add_u32 s60, s63, 128
    s_cmp_ge_u32 s60, 640
    s_cbranch_scc1 L_skipd3_4
    s_add_u32 s68, s60, s20
    s_and_b32 s68, s68, 511
    s_add_u32 s69, s60, s21
    s_and_b32 s69, s69, 127
    s_add_u32 s69, s69, 384
    s_cmp_lt_u32 s60, 512
    s_cselect_b32 s68, s68, s69
    s_cselect_b32 s36, s16, s6
    s_cselect_b32 s37, s17, s7
    s_lshl_b32 s68, s68, 13
    s_add_u32 s68, s68, s58
    s_cmp_lt_u32 s60, 640
    s_cselect_b32 s68, s68, 0x40000000
    s_add_u32 s69, s68, 4096
    buffer_load_dwordx4 v[8:11], v2, s[36:39], s68 offen offset:0 nt
    buffer_load_dwordx4 v[12:15], v2, s[36:39], s68 offen offset:64 nt
    buffer_load_dwordx4 v[16:19], v2, s[36:39], s68 offen offset:128 nt
    buffer_load_dwordx4 v[20:23], v2, s[36:39], s68 offen offset:192 nt
    buffer_load_dwordx4 v[24:27], v2, s[36:39], s69 offen offset:0 nt
    buffer_load_dwordx4 v[28:31], v2, s[36:39], s69 offen offset:64 nt
    buffer_load_dwordx4 v[32:35], v2, s[36:39], s69 offen offset:128 nt
    buffer_load_dwordx4 v[36:39], v2, s[36:39], s69 offen offset:192 nt
L_skipd3_4:
    s_nop 7
    v_mfma_f32_16x16x32_bf16 v[212:215], v[232:235], v[224:227], v[212:215]
L_tile4:
L_cont4:
    s_waitcnt vmcnt(16)
    s_cmp_lt_u32 s64, 320
    s_cbranch_scc1 L_awK4
    s_waitcnt vmcnt(8)
L_awK4:
    v_mfma_f32_16x16x32_bf16 v[216:219], v[104:107], v[168:171], 0
    v_mfma_f32_16x16x32_bf16 v[220:223], v[120:123], v[168:171], 0
    v_mfma_f32_16x16x32_bf16 v[216:219], v[108:111], v[172:175], v[216:219]
    v_mfma_f32_16x16x32_bf16 v[220:223], v[124:127], v[172:175], v[220:223]
    v_mfma_f32_16x16x32_bf16 v[216:219], v[112:115], v[176:179], v[216:219]
    v_mfma_f32_16x16x32_bf16 v[220:223], v[128:131], v[176:179], v[220:223]
    v_mfma_f32_16x16x32_bf16 v[216:219], v[116:119], v[180:183], v[216:219]
    v_mfma_f32_16x16x32_bf16 v[220:223], v[132:135], v[180:183], v[220:223]
    s_cmp_ge_u32 s60, 640
    s_cbranch_scc1 L_skipd4_3
    s_add_u32 s68, s60, s20
    s_and_b32 s68, s68, 511
    s_add_u32 s69, s60, s21
    s_and_b32 s69, s69, 127
    s_add_u32 s69, s69, 384
    s_cmp_lt_u32 s60, 512
    s_cselect_b32 s68, s68, s69
    s_cselect_b32 s40, s18, s8
    s_cselect_b32 s41, s19, s9
    s_lshl_b32 s68, s68, 13
    s_add_u32 s68, s68, s58
    s_cmp_lt_u32 s60, 640
    s_cselect_b32 s68, s68, 0x40000000
    s_add_u32 s69, s68, 4096
    buffer_load_dwordx4 v[40:43], v3, s[40:43], s68 offen offset:0 nt
    buffer_load_dwordx4 v[44:47], v3, s[40:43], s68 offen offset:256 nt
    buffer_load_dwordx4 v[48:51], v3, s[40:43], s68 offen offset:512 nt
    buffer_load_dwordx4 v[52:55], v3, s[40:43], s68 offen offset:768 nt
    buffer_load_dwordx4 v[56:59], v3, s[40:43], s69 offen offset:0 nt
    buffer_load_dwordx4 v[60:63], v3, s[40:43], s69 offen offset:256 nt
    buffer_load_dwordx4 v[64:67], v3, s[40:43], s69 offen offset:512 nt
    buffer_load_dwordx4 v[68:71], v3, s[40:43], s69 offen offset:768 nt
L_skipd4_3:
    s_nop 7
    v_max3_f32 v243, v216, v217, v218
    v_max3_f32 v243, v243, v219, v220
    v_max3_f32 v243, v243, v221, v222
    v_max_f32 v243, v243, v223
    v_mov_b32 v244, v243
    s_nop 1
    v_permlane16_swap_b32 v244, v243
    v_max_f32 v243, v243, v244
    v_mov_b32 v244, v243
    s_nop 1
    v_permlane32_swap_b32 v244, v243
    v_max_f32 v243, v243, v244
    v_mul_f32 v243, s53, v243
    v_max_f32 v243, v243, v241
    v_sub_f32 v240, v241, v243
    v_exp_f32 v240, v240
    v_mov_b32 v241, v243
    v_fma_f32 v216, v216, s53, -v241
    v_fma_f32 v217, v217, s53, -v241
    v_fma_f32 v218, v218, s53, -v241
    v_fma_f32 v219, v219, s53, -v241
    v_fma_f32 v220, v220, s53, -v241
    v_fma_f32 v221, v221, s53, -v241
    v_fma_f32 v222, v222, s53, -v241
    v_fma_f32 v223, v223, s53, -v241
    v_exp_f32 v216, v216
    v_exp_f32 v217, v217
    v_exp_f32 v218, v218
    v_exp_f32 v219, v219
    v_exp_f32 v220, v220
    v_exp_f32 v221, v221
    v_exp_f32 v222, v222
    v_exp_f32 v223, v223
    v_pk_mul_f32 v[184:185], v[184:185], v[240:241] op_sel_hi:[1,0]
    v_pk_mul_f32 v[186:187], v[186:187], v[240:241] op_sel_hi:[1,0]
    v_pk_mul_f32 v[188:189], v[188:189], v[240:241] op_sel_hi:[1,0]
    v_pk_mul_f32 v[190:191], v[190:191], v[240:241] op_sel_hi:[1,0]
    v_pk_mul_f32 v[192:193], v[192:193], v[240:241] op_sel_hi:[1,0]
    v_pk_mul_f32 v[194:195], v[194:195], v[240:241] op_sel_hi:[1,0]
    v_pk_mul_f32 v[196:197], v[196:197], v[240:241] op_sel_hi:[1,0]
    v_pk_mul_f32 v[198:199], v[198:199], v[240:241] op_sel_hi:[1,0]
    v_pk_mul_f32 v[200:201], v[200:201], v[240:241] op_sel_hi:[1,0]
    v_pk_mul_f32 v[202:203], v[202:203], v[240:241] op_sel_hi:[1,0]
    v_pk_mul_f32 v[204:205], v[204:205], v[240:241] op_sel_hi:[1,0]
    v_pk_mul_f32 v[206:207], v[206:207], v[240:241] op_sel_hi:[1,0]
    v_pk_mul_f32 v[208:209], v[208:209], v[240:241] op_sel_hi:[1,0]
    v_pk_mul_f32 v[210:211], v[210:211], v[240:241] op_sel_hi:[1,0]
    v_pk_mul_f32 v[212:213], v[212:213], v[240:241] op_sel_hi:[1,0]
    v_pk_mul_f32 v[214:215], v[214:215], v[240:241] op_sel_hi:[1,0]
    v_cvt_pk_bf16_f32 v224, v216, v217
    v_cvt_pk_bf16_f32 v225, v218, v219
    v_cvt_pk_bf16_f32 v226, v220, v221
    v_cvt_pk_bf16_f32 v227, v222, v223
    v_mul_f32 v242, v242, v240
    v_add_f32 v243, v216, v217
    v_add_f32 v244, v218, v219
    v_add_f32 v245, v220, v221
    v_add_f32 v243, v243, v244
    v_add_f32 v244, v222, v223
    v_add_f32 v243, v243, v245
    v_add_f32 v242, v242, v244
    v_add_f32 v242, v242, v243
    s_waitcnt vmcnt(16)
    s_cmp_lt_u32 s64, 320
    s_cbranch_scc1 L_awV4
    s_waitcnt vmcnt(0)
L_awV4:
    v_perm_b32 v228, v140, v136, s54
    v_perm_b32 v229, v148, v144, s54
    v_perm_b32 v230, v156, v152, s54
    v_perm_b32 v231, v164, v160, s54
    s_nop 1
    v_mfma_f32_16x16x32_bf16 v[184:187], v[228:231], v[224:227], v[184:187]
    v_perm_b32 v232, v140, v136, s55
    v_perm_b32 v233, v148, v144, s55
    v_perm_b32 v234, v156, v152, s55
    v_perm_b32 v235, v164, v160, s55
    s_nop 1
    v_mfma_f32_16x16x32_bf16 v[188:191], v[232:235], v[224:227], v[188:191]
    v_perm_b32 v236, v141, v137, s54
    v_perm_b32 v237, v149, v145, s54
    v_perm_b32 v238, v157, v153, s54
    v_perm_b32 v239, v165, v161, s54
    s_nop 1
    v_mfma_f32_16x16x32_bf16 v[192:195], v[236:239], v[224:227], v[192:195]
    v_perm_b32 v228, v141, v137, s55
    v_perm_b32 v229, v149, v145, s55
    v_perm_b32 v230, v157, v153, s55
    v_perm_b32 v231, v165, v161, s55
    s_nop 1
    v_mfma_f32_16x16x32_bf16 v[196:199], v[228:231], v[224:227], v[196:199]
    v_perm_b32 v232, v142, v138, s54
    v_perm_b32 v233, v150, v146, s54
    v_perm_b32 v234, v158, v154, s54
    v_perm_b32 v235, v166, v162, s54
    s_nop 1
    v_mfma_f32_16x16x32_bf16 v[200:203], v[232:235], v[224:227], v[200:203]
    v_perm_b32 v236, v142, v138, s55
    v_perm_b32 v237, v150, v146, s55
    v_perm_b32 v238, v158, v154, s55
    v_perm_b32 v239, v166, v162, s55
    s_nop 1
    v_mfma_f32_16x16x32_bf16 v[204:207], v[236:239], v[224:227], v[204:207]
    v_perm_b32 v228, v143, v139, s54
    v_perm_b32 v229, v151, v147, s54
    v_perm_b32 v230, v159, v155, s54
    v_perm_b32 v231, v167, v163, s54
    s_nop 1
    v_mfma_f32_16x16x32_bf16 v[208:211], v[228:231], v[224:227], v[208:211]
    v_perm_b32 v232, v143, v139, s55
    v_perm_b32 v233, v151, v147, s55
    v_perm_b32 v234, v159, v155, s55
    v_perm_b32 v235, v167, v163, s55
    s_add_u32 s61, s64, 128
    s_cmp_ge_u32 s61, 640
    s_cbranch_scc1 L_skipd4_4
    s_add_u32 s68, s61, s20
    s_and_b32 s68, s68, 511
    s_add_u32 s69, s61, s21
    s_and_b32 s69, s69, 127
    s_add_u32 s69, s69, 384
    s_cmp_lt_u32 s61, 512
    s_cselect_b32 s68, s68, s69
    s_cselect_b32 s36, s16, s6
    s_cselect_b32 s37, s17, s7
    s_lshl_b32 s68, s68, 13
    s_add_u32 s68, s68, s58
    s_cmp_lt_u32 s61, 640
    s_cselect_b32 s68, s68, 0x40000000
    s_add_u32 s69, s68, 4096
    buffer_load_dwordx4 v[72:75], v2, s[36:39], s68 offen offset:0 nt
    buffer_load_dwordx4 v[76:79], v2, s[36:39], s68 offen offset:64 nt
    buffer_load_dwordx4 v[80:83], v2, s[36:39], s68 offen offset:128 nt
    buffer_load_dwordx4 v[84:87], v2, s[36:39], s68 offen offset:192 nt
    buffer_load_dwordx4 v[88:91], v2, s[36:39], s69 offen offset:0 nt
    buffer_load_dwordx4 v[92:95], v2, s[36:39], s69 offen offset:64 nt
    buffer_load_dwordx4 v[96:99], v2, s[36:39], s69 offen offset:128 nt
    buffer_load_dwordx4 v[100:103], v2, s[36:39], s69 offen offset:192 nt
L_skipd4_4:
    s_nop 7
    v_mfma_f32_16x16x32_bf16 v[212:215], v[232:235], v[224:227], v[212:215]
    s_branch L_tile0
L_switch3:
    ds_read_b128 v[168:171], v4 offset:4096
    ds_read_b128 v[172:175], v4 offset:4352
    ds_read_b128 v[176:179], v4 offset:4608
    ds_read_b128 v[180:183], v4 offset:4864
    v_mov_b32 v243, v242
    s_nop 1
    v_permlane16_swap_b32 v243, v242
    v_add_f32 v242, v242, v243
    v_mov_b32 v243, v242
    s_nop 1
    v_permlane32_swap_b32 v243, v242
    v_add_f32 v242, v242, v243
    s_and_saveexec_b64 s[74:75], s[72:73]
    ds_write_b128 v6, v[184:187] offset:10240
    ds_write_b128 v6, v[188:191] offset:10304
    ds_write_b128 v6, v[192:195] offset:10368
    ds_write_b128 v6, v[196:199] offset:10432
    ds_write_b128 v6, v[200:203] offset:10496
    ds_write_b128 v6, v[204:207] offset:10560
    ds_write_b128 v6, v[208:211] offset:10624
    ds_write_b128 v6, v[212:215] offset:10688
    v_add_u32 v244, 24608, v7
    ds_write2_b32 v244, v241, v242 offset0:0 offset1:1
    s_mov_b64 exec, s[74:75]
    v_lshrrev_b32 v243, 5, v0
    v_and_b32 v244, 31, v0
    v_lshlrev_b32 v246, 3, v243
    v_lshlrev_b32 v247, 9, v243
    v_and_b32 v245, 1, v244
    v_lshl_add_u32 v247, v245, 8, v247
    v_lshrrev_b32 v245, 3, v244
    v_lshl_add_u32 v247, v245, 4, v247
    v_bfe_u32 v245, v244, 1, 2
    v_lshl_add_u32 v247, v245, 2, v247
    v_add_u32 v247, 8192, v247
    v_add_u32 v248, 4096, v247
    v_add_u32 v249, 8192, v247
    v_add_u32 v250, 12288, v247
    v_lshrrev_b32 v252, 7, v0
    v_bfe_u32 v245, v0, 5, 2
    v_lshlrev_b32 v252, 10, v252
    v_lshl_add_u32 v252, v245, 4, v252
    s_lshl_b32 s68, s56, 6
    s_add_u32 s68, s68, s57
    v_add_u32 v252, s68, v252
    v_lshlrev_b32 v251, 9, v252
    v_lshl_add_u32 v251, v244, 4, v251
    v_lshlrev_b32 v252, 3, v252
    v_cmp_eq_u32 s[14:15], 0, v244
    s_waitcnt lgkmcnt(0)
    s_mov_b32 s26, 1
    s_branch L_exit
L_dry1_back:
    s_mov_b32 s26, 0
    s_setprio 0
    v_mov_b32 v184, 0
    v_mov_b32 v185, 0
    v_mov_b32 v186, 0
    v_mov_b32 v187, 0
    v_mov_b32 v188, 0
    v_mov_b32 v189, 0
    v_mov_b32 v190, 0
    v_mov_b32 v191, 0
    v_mov_b32 v192, 0
    v_mov_b32 v193, 0
    v_mov_b32 v194, 0
    v_mov_b32 v195, 0
    v_mov_b32 v196, 0
    v_mov_b32 v197, 0
    v_mov_b32 v198, 0
    v_mov_b32 v199, 0
    v_mov_b32 v200, 0
    v_mov_b32 v201, 0
    v_mov_b32 v202, 0
    v_mov_b32 v203, 0
    v_mov_b32 v204, 0
    v_mov_b32 v205, 0
    v_mov_b32 v206, 0
    v_mov_b32 v207, 0
    v_mov_b32 v208, 0
    v_mov_b32 v209, 0
    v_mov_b32 v210, 0
    v_mov_b32 v211, 0
    v_mov_b32 v212, 0
    v_mov_b32 v213, 0
    v_mov_b32 v214, 0
    v_mov_b32 v215, 0
    v_mov_b32 v241, 0xff7fffff
    v_mov_b32 v242, 0
    s_mov_b32 s59, -1
    s_waitcnt lgkmcnt(0)
    s_branch L_cont3
L_exit:
    s_cmp_lg_u32 s26, 0
    s_cbranch_scc1 L_exit_nowo
    s_mov_b32 m0, s67
    s_nop 0
    buffer_load_dwordx4 v254, s[48:51], s65 offen offset:0 nt lds
    buffer_load_dwordx4 v254, s[48:51], s65 offen offset:1024 nt lds
    buffer_load_dwordx4 v254, s[48:51], s65 offen offset:2048 nt lds
    buffer_load_dwordx4 v254, s[48:51], s65 offen offset:3072 nt lds
L_exit_nowo:
    v_mov_b32 v243, v242
    s_nop 1
    v_permlane16_swap_b32 v243, v242
    v_add_f32 v242, v242, v243
    v_mov_b32 v243, v242
    s_nop 1
    v_permlane32_swap_b32 v243, v242
    v_add_f32 v242, v242, v243
    s_and_saveexec_b64 s[74:75], s[72:73]
    ds_write_b128 v6, v[184:187] offset:8192
    ds_write_b128 v6, v[188:191] offset:8256
    ds_write_b128 v6, v[192:195] offset:8320
    ds_write_b128 v6, v[196:199] offset:8384
    ds_write_b128 v6, v[200:203] offset:8448
    ds_write_b128 v6, v[204:207] offset:8512
    ds_write_b128 v6, v[208:211] offset:8576
    ds_write_b128 v6, v[212:215] offset:8640
    v_add_u32 v244, 24576, v7
    ds_write2_b32 v244, v241, v242 offset0:0 offset1:1
    s_mov_b64 exec, s[74:75]
    s_waitcnt lgkmcnt(0)
    s_cmp_lg_u32 s26, 0
    s_cbranch_scc1 L_exit_nobar
    s_barrier
L_exit_nobar:
    s_setprio 3
    ds_read_b64 v[184:185], v246 offset:24576
    ds_read_b64 v[186:187], v246 offset:24640
    ds_read_b64 v[188:189], v246 offset:24704
    ds_read_b64 v[190:191], v246 offset:24768
    ds_read2_b32 v[192:193], v247 offset0:0 offset1:16
    ds_read2_b32 v[194:195], v247 offset0:32 offset1:48
    ds_read2_b32 v[196:197], v248 offset0:0 offset1:16
    ds_read2_b32 v[198:199], v248 offset0:32 offset1:48
    ds_read2_b32 v[200:201], v249 offset0:0 offset1:16
    ds_read2_b32 v[202:203], v249 offset0:32 offset1:48
    ds_read2_b32 v[204:205], v250 offset0:0 offset1:16
    ds_read2_b32 v[206:207], v250 offset0:32 offset1:48
    v_mov_b32 v209, s52
    v_mov_b32 v211, s52
    s_waitcnt lgkmcnt(8)
    v_max3_f32 v216, v184, v186, v188
    v_max_f32 v216, v216, v190
    v_sub_f32 v184, v184, v216
    v_sub_f32 v186, v186, v216
    v_sub_f32 v188, v188, v216
    v_sub_f32 v190, v190, v216
    v_exp_f32 v184, v184
    v_exp_f32 v186, v186
    v_exp_f32 v188, v188
    v_exp_f32 v190, v190
    v_mul_f32 v217, v184, v185
    v_fmac_f32 v217, v186, v187
    v_fmac_f32 v217, v188, v189
    v_fmac_f32 v217, v190, v191
    v_rcp_f32 v243, v217
    v_log_f32 v244, v217
    s_waitcnt lgkmcnt(0)
    v_mul_f32 v220, v192, v184
    v_mul_f32 v221, v193, v184
    v_mul_f32 v222, v194, v184
    v_mul_f32 v223, v195, v184
    v_add_f32 v216, v216, v244
    v_fmac_f32 v220, v196, v186
    v_fmac_f32 v221, v197, v186
    v_fmac_f32 v222, v198, v186
    v_fmac_f32 v223, v199, v186
    v_fmac_f32 v220, v200, v188
    v_fmac_f32 v221, v201, v188
    v_fmac_f32 v222, v202, v188
    v_fmac_f32 v223, v203, v188
    v_fmac_f32 v220, v204, v190
    v_fmac_f32 v221, v205, v190
    v_fmac_f32 v222, v206, v190
    v_fmac_f32 v223, v207, v190
    v_mov_b32 v217, s52
    s_cmp_lg_u32 s26, 0
    s_cbranch_scc1 L_exit_nost
    s_mov_b32 s69, 131072
    s_and_saveexec_b64 s[74:75], s[14:15]
    buffer_store_dwordx2 v[216:217], v252, s[32:35], s69 offen sc1
    s_mov_b64 exec, s[74:75]
L_exit_nost:
    v_mul_f32 v220, v220, v243
    v_mul_f32 v221, v221, v243
    v_mul_f32 v222, v222, v243
    v_mul_f32 v223, v223, v243
    v_cvt_pk_bf16_f32 v208, v220, v221
    v_cvt_pk_bf16_f32 v210, v222, v223
    s_cmp_lg_u32 s26, 0
    s_cbranch_scc1 L_dry1_back
    s_mov_b32 s69, 1048576
    buffer_store_dwordx4 v[208:211], v251, s[32:35], s69 offen sc1
    s_barrier
    s_add_u32 m0, s67, 4096
    s_nop 0
    buffer_load_dwordx4 v254, s[48:51], s66 offen offset:0 nt lds
    buffer_load_dwordx4 v254, s[48:51], s66 offen offset:1024 nt lds
    buffer_load_dwordx4 v254, s[48:51], s66 offen offset:2048 nt lds
    buffer_load_dwordx4 v254, s[48:51], s66 offen offset:3072 nt lds
    s_lshr_b32 s10, s2, 7
    s_bfe_u32 s11, s2, 0x50002
    s_lshr_b32 s22, s11, 2
    s_and_b32 s23, s11, 3
    s_lshl_b32 s20, s10, 4
    s_add_u32 s20, s20, s22
    s_lshl_b32 s20, s20, 2
    s_add_u32 s20, s20, s23
    s_lshl_b32 s20, s20, 4
    s_lshl_b32 s21, s20, 3
    s_add_u32 s21, s21, 131072
    v_bfe_u32 v243, v5, 4, 1
    v_lshrrev_b32 v244, 5, v5
    v_lshlrev_b32 v169, 9, v243
    v_lshl_add_u32 v169, v244, 3, v169
    v_lshlrev_b32 v169, 9, v169
    v_and_b32 v245, 15, v5
    v_lshl_add_u32 v169, v245, 3, v169
    v_lshlrev_b32 v170, 6, v243
    v_lshl_add_u32 v170, v244, 5, v170
    v_lshlrev_b32 v171, 8, v243
    v_lshl_add_u32 v171, v245, 2, v171
    s_lshl_b32 s68, s3, 6
    v_add_u32 v171, s68, v171
    v_and_b32 v172, 1, v5
    v_lshlrev_b32 v172, 8, v172
    v_lshrrev_b32 v245, 4, v5
    v_lshl_add_u32 v172, v245, 4, v172
    v_and_b32 v173, 1, v5
    v_lshl_add_u32 v173, v173, 2, v245
    v_lshlrev_b32 v173, 4, v173
    s_lshl_b32 s68, s3, 9
    v_add_u32 v173, s68, v173
    v_and_b32 v243, 15, v5
    v_cmp_gt_u32 s[14:15], 2, v243
    s_lshl_b32 s20, s20, 9
    s_lshl_b32 s68, s3, 7
    s_add_u32 s20, s20, s68
    s_add_u32 s20, s20, 1048576
    s_lshl_b32 s68, s10, 2
    s_and_b32 s69, s2, 3
    s_add_u32 s68, s68, s69
    s_lshl_b32 s68, s68, 16
    s_add_u32 s22, s68, 2097152
    s_lshl_b32 s68, s11, 11
    s_add_u32 s23, s22, s68
    v_bfe_u32 v168, v5, 3, 1
    v_lshlrev_b32 v168, 12, v168
    v_and_b32 v243, 7, v5
    v_lshl_add_u32 v168, v243, 4, v168
    s_mov_b32 s26, 1
    s_cmp_lg_u32 s3, 0
    s_cbranch_scc1 L_g1_unpack
    s_branch L_g1_w
L_dry_back:
    s_mov_b32 s26, 0
    s_cmp_lg_u32 s3, 0
    s_cbranch_scc1 L_g1_a
    s_mov_b32 s4, 131072
L_g1_poll:
    buffer_load_dwordx4 v[216:219], v168, s[32:35], s21 offen sc1
    s_waitcnt vmcnt(0)
    v_cmp_eq_u32 vcc, s52, v217
    v_cmp_eq_u32 s[68:69], s52, v219
    s_bcnt1_i32_b64 s70, vcc
    s_bcnt1_i32_b64 s71, s[68:69]
    s_add_u32 s70, s70, s71
    s_cmp_ge_u32 s70, 120
    s_cbranch_scc1 L_g1_a
    s_sub_u32 s4, s4, 1
    s_cbranch_scc0 L_g1_poll
L_g1_a:
    s_waitcnt vmcnt(0)
    s_barrier
    s_mov_b32 s4, 131072
    s_cmp_lg_u32 s3, 0
    s_cbranch_scc1 L_g1_nost
    buffer_load_dwordx4 v[216:219], v168, s[32:35], s21 offen sc1
L_g1_nost:
    buffer_load_dwordx2 v[200:201], v169, s[32:35], s20 offen offset:0 sc1
    buffer_load_dwordx2 v[202:203], v169, s[32:35], s20 offen offset:512 sc1
    buffer_load_dwordx2 v[204:205], v169, s[32:35], s20 offen offset:1024 sc1
    buffer_load_dwordx2 v[206:207], v169, s[32:35], s20 offen offset:1536 sc1
    buffer_load_dwordx2 v[208:209], v169, s[32:35], s20 offen offset:2048 sc1
    buffer_load_dwordx2 v[210:211], v169, s[32:35], s20 offen offset:2560 sc1
    buffer_load_dwordx2 v[212:213], v169, s[32:35], s20 offen offset:3072 sc1
    buffer_load_dwordx2 v[214:215], v169, s[32:35], s20 offen offset:3584 sc1
    v_lshlrev_b32 v178, 4, v5
    s_lshl_b32 s68, s3, 2
    v_add_u32 v178, s68, v178
    ds_read2st64_b32 v[8:9], v178 offset0:100 offset1:104
    ds_read2st64_b32 v[10:11], v178 offset0:108 offset1:112
    ds_read2st64_b32 v[12:13], v178 offset0:116 offset1:120
    ds_read2st64_b32 v[14:15], v178 offset0:124 offset1:128
    ds_read2st64_b32 v[16:17], v178 offset0:132 offset1:136
    ds_read2st64_b32 v[18:19], v178 offset0:140 offset1:144
    ds_read2st64_b32 v[20:21], v178 offset0:148 offset1:152
    ds_read2st64_b32 v[22:23], v178 offset0:156 offset1:160
    ds_read2st64_b32 v[24:25], v178 offset0:164 offset1:168
    ds_read2st64_b32 v[26:27], v178 offset0:172 offset1:176
    ds_read2st64_b32 v[28:29], v178 offset0:180 offset1:184
    ds_read2st64_b32 v[30:31], v178 offset0:188 offset1:192
    ds_read2st64_b32 v[32:33], v178 offset0:196 offset1:200
    ds_read2st64_b32 v[34:35], v178 offset0:204 offset1:208
    ds_read2st64_b32 v[36:37], v178 offset0:212 offset1:216
    ds_read2st64_b32 v[38:39], v178 offset0:220 offset1:224
    s_waitcnt lgkmcnt(0)
    v_perm_b32 v136, v9, v8, s54
    v_perm_b32 v137, v11, v10, s54
    v_perm_b32 v138, v13, v12, s54
    v_perm_b32 v139, v15, v14, s54
    v_perm_b32 v140, v9, v8, s55
    v_perm_b32 v141, v11, v10, s55
    v_perm_b32 v142, v13, v12, s55
    v_perm_b32 v143, v15, v14, s55
    v_perm_b32 v144, v17, v16, s54
    v_perm_b32 v145, v19, v18, s54
    v_perm_b32 v146, v21, v20, s54
    v_perm_b32 v147, v23, v22, s54
    v_perm_b32 v148, v17, v16, s55
    v_perm_b32 v149, v19, v18, s55
    v_perm_b32 v150, v21, v20, s55
    v_perm_b32 v151, v23, v22, s55
    v_perm_b32 v152, v25, v24, s54
    v_perm_b32 v153, v27, v26, s54
    v_perm_b32 v154, v29, v28, s54
    v_perm_b32 v155, v31, v30, s54
    v_perm_b32 v156, v25, v24, s55
    v_perm_b32 v157, v27, v26, s55
    v_perm_b32 v158, v29, v28, s55
    v_perm_b32 v159, v31, v30, s55
    v_perm_b32 v160, v33, v32, s54
    v_perm_b32 v161, v35, v34, s54
    v_perm_b32 v162, v37, v36, s54
    v_perm_b32 v163, v39, v38, s54
    v_perm_b32 v164, v33, v32, s55
    v_perm_b32 v165, v35, v34, s55
    v_perm_b32 v166, v37, v36, s55
    v_perm_b32 v167, v39, v38, s55
    s_cmp_lg_u32 s3, 0
    s_cbranch_scc1 L_g1_ochk
    s_branch L_g1_ochk0
    s_cmp_lg_u32 s3, 0
    s_cbranch_scc1 L_g1_opoll
L_g1_opoll0:
    buffer_load_dwordx4 v[216:219], v168, s[32:35], s21 offen sc1
    buffer_load_dwordx2 v[200:201], v169, s[32:35], s20 offen offset:0 sc1
    buffer_load_dwordx2 v[202:203], v169, s[32:35], s20 offen offset:512 sc1
    buffer_load_dwordx2 v[204:205], v169, s[32:35], s20 offen offset:1024 sc1
    buffer_load_dwordx2 v[206:207], v169, s[32:35], s20 offen offset:1536 sc1
    buffer_load_dwordx2 v[208:209], v169, s[32:35], s20 offen offset:2048 sc1
    buffer_load_dwordx2 v[210:211], v169, s[32:35], s20 offen offset:2560 sc1
    buffer_load_dwordx2 v[212:213], v169, s[32:35], s20 offen offset:3072 sc1
    buffer_load_dwordx2 v[214:215], v169, s[32:35], s20 offen offset:3584 sc1
L_g1_ochk0:
    s_waitcnt vmcnt(0)
    v_cmp_eq_u32 vcc, s52, v201
    v_cmp_eq_u32 s[68:69], s52, v203
    s_nop 0
    s_and_b64 vcc, vcc, s[68:69]
    v_cmp_eq_u32 s[68:69], s52, v205
    s_nop 0
    s_and_b64 vcc, vcc, s[68:69]
    v_cmp_eq_u32 s[68:69], s52, v207
    s_nop 0
    s_and_b64 vcc, vcc, s[68:69]
    v_cmp_eq_u32 s[68:69], s52, v209
    s_nop 0
    s_and_b64 vcc, vcc, s[68:69]
    v_cmp_eq_u32 s[68:69], s52, v211
    s_nop 0
    s_and_b64 vcc, vcc, s[68:69]
    v_cmp_eq_u32 s[68:69], s52, v213
    s_nop 0
    s_and_b64 vcc, vcc, s[68:69]
    v_cmp_eq_u32 s[68:69], s52, v215
    s_nop 0
    s_and_b64 vcc, vcc, s[68:69]
    v_cmp_eq_u32 s[68:69], s52, v217
    s_nop 0
    s_and_b64 vcc, vcc, s[68:69]
    v_cmp_eq_u32 s[68:69], s52, v219
    s_nop 0
    s_and_b64 vcc, vcc, s[68:69]
    s_cmp_eq_u64 vcc, exec
    s_cbranch_scc1 L_g1_w
    s_sub_u32 s4, s4, 1
    s_cbranch_scc0 L_g1_opoll0
L_g1_w:
    v_max_f32 v243, v216, v218
    s_nop 1
    v_max_f32_dpp v243, v243, v243 quad_perm:[1,0,3,2] row_mask:0xf bank_mask:0xf
    s_nop 1
    v_max_f32_dpp v243, v243, v243 quad_perm:[2,3,0,1] row_mask:0xf bank_mask:0xf
    s_nop 1
    v_max_f32_dpp v243, v243, v243 row_half_mirror row_mask:0xf bank_mask:0xf
    v_sub_f32 v216, v216, v243
    v_sub_f32 v218, v218, v243
    v_exp_f32 v216, v216
    v_exp_f32 v217, v218
    v_and_b32 v244, 15, v5
    v_lshlrev_b32 v244, 3, v244
    v_add_f32 v243, v216, v217
    s_nop 1
    v_add_f32_dpp v243, v243, v243 quad_perm:[1,0,3,2] row_mask:0xf bank_mask:0xf
    s_nop 1
    v_add_f32_dpp v243, v243, v243 quad_perm:[2,3,0,1] row_mask:0xf bank_mask:0xf
    s_nop 1
    v_add_f32_dpp v243, v243, v243 row_half_mirror row_mask:0xf bank_mask:0xf
    v_rcp_f32 v243, v243
    s_nop 0
    v_mul_f32 v216, v216, v243
    v_mul_f32 v217, v217, v243
    ds_write_b64 v244, v[216:217] offset:25344
    s_branch L_g1_unpack
L_g1_opoll:
    buffer_load_dwordx2 v[200:201], v169, s[32:35], s20 offen offset:0 sc1
    buffer_load_dwordx2 v[202:203], v169, s[32:35], s20 offen offset:512 sc1
    buffer_load_dwordx2 v[204:205], v169, s[32:35], s20 offen offset:1024 sc1
    buffer_load_dwordx2 v[206:207], v169, s[32:35], s20 offen offset:1536 sc1
    buffer_load_dwordx2 v[208:209], v169, s[32:35], s20 offen offset:2048 sc1
    buffer_load_dwordx2 v[210:211], v169, s[32:35], s20 offen offset:2560 sc1
    buffer_load_dwordx2 v[212:213], v169, s[32:35], s20 offen offset:3072 sc1
    buffer_load_dwordx2 v[214:215], v169, s[32:35], s20 offen offset:3584 sc1
L_g1_ochk:
    s_waitcnt vmcnt(0)
    v_cmp_eq_u32 vcc, s52, v201
    v_cmp_eq_u32 s[68:69], s52, v203
    s_nop 0
    s_and_b64 vcc, vcc, s[68:69]
    v_cmp_eq_u32 s[68:69], s52, v205
    s_nop 0
    s_and_b64 vcc, vcc, s[68:69]
    v_cmp_eq_u32 s[68:69], s52, v207
    s_nop 0
    s_and_b64 vcc, vcc, s[68:69]
    v_cmp_eq_u32 s[68:69], s52, v209
    s_nop 0
    s_and_b64 vcc, vcc, s[68:69]
    v_cmp_eq_u32 s[68:69], s52, v211
    s_nop 0
    s_and_b64 vcc, vcc, s[68:69]
    v_cmp_eq_u32 s[68:69], s52, v213
    s_nop 0
    s_and_b64 vcc, vcc, s[68:69]
    v_cmp_eq_u32 s[68:69], s52, v215
    s_nop 0
    s_and_b64 vcc, vcc, s[68:69]
    s_cmp_eq_u64 vcc, exec
    s_cbranch_scc1 L_g1_unpack
    s_sub_u32 s4, s4, 1
    s_cbranch_scc0 L_g1_opoll
L_g1_unpack:
    v_lshlrev_b32 v201, 16, v200
    v_and_b32 v200, 0xffff0000, v200
    v_lshlrev_b32 v203, 16, v202
    v_and_b32 v202, 0xffff0000, v202
    v_lshlrev_b32 v205, 16, v204
    v_and_b32 v204, 0xffff0000, v204
    v_lshlrev_b32 v207, 16, v206
    v_and_b32 v206, 0xffff0000, v206
    v_lshlrev_b32 v209, 16, v208
    v_and_b32 v208, 0xffff0000, v208
    v_lshlrev_b32 v211, 16, v210
    v_and_b32 v210, 0xffff0000, v210
    v_lshlrev_b32 v213, 16, v212
    v_and_b32 v212, 0xffff0000, v212
    v_lshlrev_b32 v215, 16, v214
    v_and_b32 v214, 0xffff0000, v214
    s_waitcnt lgkmcnt(0)
    s_cmp_lg_u32 s26, 0
    s_cbranch_scc1 L_nobarB
    s_barrier
L_nobarB:
    ds_read_b128 v[184:187], v170 offset:25344
    ds_read_b128 v[188:191], v170 offset:25360
    v_mov_b32 v217, s52
    v_mov_b32 v219, s52
    v_mov_b32 v221, s52
    v_mov_b32 v223, s52
    v_mov_b32 v225, s52
    v_mov_b32 v227, s52
    v_mov_b32 v229, s52
    v_mov_b32 v231, s52
    s_waitcnt lgkmcnt(0)
    v_mul_f32 v243, v184, v201
    v_mul_f32 v244, v184, v200
    v_fmac_f32 v243, v185, v203
    v_fmac_f32 v244, v185, v202
    v_fmac_f32 v243, v186, v205
    v_fmac_f32 v244, v186, v204
    v_fmac_f32 v243, v187, v207
    v_fmac_f32 v244, v187, v206
    v_fmac_f32 v243, v188, v209
    v_fmac_f32 v244, v188, v208
    v_fmac_f32 v243, v189, v211
    v_fmac_f32 v244, v189, v210
    v_fmac_f32 v243, v190, v213
    v_fmac_f32 v244, v190, v212
    v_fmac_f32 v243, v191, v215
    v_fmac_f32 v244, v191, v214
    v_mov_b32 v245, v243
    v_mov_b32 v240, v244
    s_nop 0
    v_permlane32_swap_b32 v245, v243
    v_permlane32_swap_b32 v240, v244
    v_add_f32 v243, v243, v245
    v_add_f32 v244, v244, v240
    v_cvt_pk_bf16_f32 v243, v243, v244
    ds_write_b32 v171, v243 offset:24832
    s_waitcnt lgkmcnt(0)
    s_cmp_lg_u32 s26, 0
    s_cbranch_scc1 L_nobarC
    s_barrier
L_nobarC:
    ds_read_b128 v[200:203], v172 offset:24832
    ds_read_b128 v[204:207], v172 offset:24896
    ds_read_b128 v[208:211], v172 offset:24960
    ds_read_b128 v[212:215], v172 offset:25024
    s_waitcnt lgkmcnt(3)
    v_mfma_f32_16x16x32_bf16 v[184:187], v[136:139], v[200:203], 0
    v_mfma_f32_16x16x32_bf16 v[188:191], v[140:143], v[200:203], 0
    s_waitcnt lgkmcnt(2)
    v_mfma_f32_16x16x32_bf16 v[184:187], v[144:147], v[204:207], v[184:187]
    v_mfma_f32_16x16x32_bf16 v[188:191], v[148:151], v[204:207], v[188:191]
    s_waitcnt lgkmcnt(1)
    v_mfma_f32_16x16x32_bf16 v[184:187], v[152:155], v[208:211], v[184:187]
    v_mfma_f32_16x16x32_bf16 v[188:191], v[156:159], v[208:211], v[188:191]
    s_waitcnt lgkmcnt(0)
    v_mfma_f32_16x16x32_bf16 v[184:187], v[160:163], v[212:215], v[184:187]
    v_mfma_f32_16x16x32_bf16 v[188:191], v[164:167], v[212:215], v[188:191]
    v_and_b32 v176, 7, v5
    v_lshrrev_b32 v177, 3, v5
    v_lshlrev_b32 v174, 11, v177
    v_lshl_add_u32 v174, v176, 3, v174
    s_nop 2
    v_mov_b32 v216, v184
    v_mov_b32 v218, v188
    v_mov_b32 v220, v185
    v_mov_b32 v222, v189
    v_mov_b32 v224, v186
    v_mov_b32 v226, v190
    v_mov_b32 v228, v187
    v_mov_b32 v230, v191
    s_cmp_lg_u32 s26, 0
    s_cbranch_scc1 L_g2_ok
    s_and_saveexec_b64 s[74:75], s[14:15]
    buffer_store_dwordx4 v[216:219], v173, s[32:35], s23 offen offset:0 sc1
    buffer_store_dwordx4 v[220:223], v173, s[32:35], s23 offen offset:128 sc1
    buffer_store_dwordx4 v[224:227], v173, s[32:35], s23 offen offset:256 sc1
    buffer_store_dwordx4 v[228:231], v173, s[32:35], s23 offen offset:384 sc1
    s_mov_b64 exec, s[74:75]
    s_cmp_lg_u32 s3, 0
    s_cbranch_scc1 L_fin
    s_lshl_b32 s68, s11, 6
    s_add_u32 s20, s22, s68
    s_add_u32 s21, s20, 16384
    s_add_u32 s22, s20, 32768
    s_add_u32 s23, s20, 49152
    s_mov_b32 s4, 131072
    buffer_load_dwordx2 v[40:41], v174, s[32:35], s20 offen sc1
    buffer_load_dwordx2 v[42:43], v174, s[32:35], s21 offen sc1
    buffer_load_dwordx2 v[44:45], v174, s[32:35], s22 offen sc1
    buffer_load_dwordx2 v[46:47], v174, s[32:35], s23 offen sc1
    v_bfe_u32 v175, v176, 1, 2
    v_lshlrev_b32 v175, 5, v175
    v_and_b32 v177, 1, v176
    v_add_u32 v175, v175, v177
    s_bfe_u32 s68, s11, 0x20001
    s_lshl_b32 s68, s68, 3
    s_lshr_b32 s69, s11, 3
    s_lshl_b32 s69, s69, 1
    s_add_u32 s68, s68, s69
    s_and_b32 s69, s11, 1
    s_lshl_b32 s69, s69, 10
    s_add_u32 s68, s68, s69
    s_lshl_b32 s69, s10, 9
    s_add_u32 s68, s68, s69
    s_and_b32 s69, s2, 3
    s_lshl_b32 s69, s69, 7
    s_add_u32 s68, s68, s69
    v_add_u32 v175, s68, v175
    v_lshlrev_b32 v175, 1, v175
    s_mov_b32 s44, s24
    s_and_b32 s45, s25, 0xffff
    s_mov_b32 s46, 0x1000
    s_mov_b32 s47, 0x20000
    v_cmp_gt_u32 s[70:71], 8, v5
    s_sleep 4
    buffer_load_dwordx2 v[48:49], v174, s[32:35], s20 offen sc1
    buffer_load_dwordx2 v[50:51], v174, s[32:35], s21 offen sc1
    buffer_load_dwordx2 v[52:53], v174, s[32:35], s22 offen sc1
    buffer_load_dwordx2 v[54:55], v174, s[32:35], s23 offen sc1
    s_sleep 4
    buffer_load_dwordx2 v[56:57], v174, s[32:35], s20 offen sc1
    buffer_load_dwordx2 v[58:59], v174, s[32:35], s21 offen sc1
    buffer_load_dwordx2 v[60:61], v174, s[32:35], s22 offen sc1
    buffer_load_dwordx2 v[62:63], v174, s[32:35], s23 offen sc1
L_g2_poll:
    s_waitcnt vmcnt(8)
    v_cmp_eq_u32 vcc, s52, v41
    v_cmp_eq_u32 s[68:69], s52, v43
    s_nop 0
    s_and_b64 vcc, vcc, s[68:69]
    v_cmp_eq_u32 s[68:69], s52, v45
    s_nop 0
    s_and_b64 vcc, vcc, s[68:69]
    v_cmp_eq_u32 s[68:69], s52, v47
    s_nop 0
    s_and_b64 vcc, vcc, s[68:69]
    s_cmp_eq_u64 vcc, exec
    s_cbranch_scc1 L_g2_ok0
    s_sub_u32 s4, s4, 1
    s_cbranch_scc1 L_g2_ok0
    buffer_load_dwordx2 v[40:41], v174, s[32:35], s20 offen sc1
    buffer_load_dwordx2 v[42:43], v174, s[32:35], s21 offen sc1
    buffer_load_dwordx2 v[44:45], v174, s[32:35], s22 offen sc1
    buffer_load_dwordx2 v[46:47], v174, s[32:35], s23 offen sc1
    s_waitcnt vmcnt(8)
    v_cmp_eq_u32 vcc, s52, v49
    v_cmp_eq_u32 s[68:69], s52, v51
    s_nop 0
    s_and_b64 vcc, vcc, s[68:69]
    v_cmp_eq_u32 s[68:69], s52, v53
    s_nop 0
    s_and_b64 vcc, vcc, s[68:69]
    v_cmp_eq_u32 s[68:69], s52, v55
    s_nop 0
    s_and_b64 vcc, vcc, s[68:69]
    s_cmp_eq_u64 vcc, exec
    s_cbranch_scc1 L_g2_ok1
    s_sub_u32 s4, s4, 1
    s_cbranch_scc1 L_g2_ok1
    buffer_load_dwordx2 v[48:49], v174, s[32:35], s20 offen sc1
    buffer_load_dwordx2 v[50:51], v174, s[32:35], s21 offen sc1
    buffer_load_dwordx2 v[52:53], v174, s[32:35], s22 offen sc1
    buffer_load_dwordx2 v[54:55], v174, s[32:35], s23 offen sc1
    s_waitcnt vmcnt(8)
    v_cmp_eq_u32 vcc, s52, v57
    v_cmp_eq_u32 s[68:69], s52, v59
    s_nop 0
    s_and_b64 vcc, vcc, s[68:69]
    v_cmp_eq_u32 s[68:69], s52, v61
    s_nop 0
    s_and_b64 vcc, vcc, s[68:69]
    v_cmp_eq_u32 s[68:69], s52, v63
    s_nop 0
    s_and_b64 vcc, vcc, s[68:69]
    s_cmp_eq_u64 vcc, exec
    s_cbranch_scc1 L_g2_ok2
    s_sub_u32 s4, s4, 1
    s_cbranch_scc1 L_g2_ok2
    buffer_load_dwordx2 v[56:57], v174, s[32:35], s20 offen sc1
    buffer_load_dwordx2 v[58:59], v174, s[32:35], s21 offen sc1
    buffer_load_dwordx2 v[60:61], v174, s[32:35], s22 offen sc1
    buffer_load_dwordx2 v[62:63], v174, s[32:35], s23 offen sc1
    s_branch L_g2_poll
L_g2_ok0:
    v_add_f32 v246, v40, v42
    v_add_f32 v250, v44, v46
    s_branch L_g2_ok
L_g2_ok1:
    v_add_f32 v246, v48, v50
    v_add_f32 v250, v52, v54
    s_branch L_g2_ok
L_g2_ok2:
    v_add_f32 v246, v56, v58
    v_add_f32 v250, v60, v62
L_g2_ok:
    v_add_f32 v246, v246, v250
    s_nop 1
    v_add_f32_dpp v246, v246, v246 row_ror:8 row_mask:0xf bank_mask:0xf
    v_mov_b32 v247, v246
    s_nop 1
    v_permlane16_swap_b32 v247, v246
    v_add_f32 v246, v246, v247
    v_mov_b32 v247, v246
    s_nop 1
    v_permlane32_swap_b32 v247, v246
    v_add_f32 v246, v246, v247
    v_cvt_pk_bf16_f32 v246, v246, v246
    s_cmp_lg_u32 s26, 0
    s_cbranch_scc1 L_dry_back
    s_and_saveexec_b64 s[74:75], s[70:71]
    buffer_store_short v246, v175, s[44:47], 0 offen
    s_mov_b64 exec, s[74:75]
    s_cmp_lg_u32 s2, 0
    s_cbranch_scc1 L_fin
    v_mov_b32 v246, s52
    v_mov_b32 v247, 0
    s_mov_b64 exec, 1
    buffer_store_dword v246, v247, s[32:35], 0 offen
    s_mov_b64 exec, -1
L_fin:
L_end:
    s_endpgm
L_codeend:

.section .rodata,"a"
.p2align 6
.amdhsa_kernel concat_heads__sliding_block_cached__gqa_block_cached__decode_kernel
  .amdhsa_next_free_vgpr 255
  .amdhsa_next_free_sgpr 100
  .amdhsa_accum_offset 256
  .amdhsa_group_segment_fixed_size 0
  .amdhsa_kernarg_size 104
  .amdhsa_user_sgpr_count 2
  .amdhsa_user_sgpr_kernarg_segment_ptr 1
  .amdhsa_system_sgpr_workgroup_id_x 1
.end_amdhsa_kernel
```
